```python
import torch

def _softmax(x, axis=-1):
    return torch.softmax(x, dim=axis)
def _gelu(x):
    return torch.nn.functional.gelu(x, approximate="tanh")
def _silu(x):
    return torch.nn.functional.silu(x)
def _sigmoid(x):
    return torch.sigmoid(x)
def _layernorm(x, axis=-1, eps=1e-5):
    m = x.mean(dim=axis, keepdim=True)
    v = x.var(dim=axis, keepdim=True, unbiased=False)
    return (x - m) / torch.sqrt(v + eps)
def _scatter_add(tgt, idx, src, axis=0):
    return tgt.clone().index_add_(axis, idx, src)
def _segment_sum(src, seg, n):
    out = torch.zeros((n,) + src.shape[1:], dtype=src.dtype)
    return out.index_add_(0, seg, src)
def _pad(x, pw):
    flat = tuple(v for pair in reversed(pw) for v in pair)
    return torch.nn.functional.pad(x, flat)

kernel_name = 'concat_heads__ssm_conv_s5__grouped_kv_mqa__prompt'

def setup_inputs():

    _w = (lambda a: (lambda t: t.to(torch.bfloat16) if t.is_floating_point() else t)(torch.as_tensor(a)))
    def _A_setup():
        B, S, D = 1, 2048, 512
        P = D
        Lambda_re = -0.5 * (lambda _x: torch.exp(torch.as_tensor(_x)))((lambda *s: torch.randn(*s, dtype=torch.bfloat16) * 0.2)(P))
        Lambda_im = (lambda *s: torch.randn(*s, dtype=torch.bfloat16) * 0.4)(P) * 1.0
        B_re = (lambda *s: torch.randn(*s, dtype=torch.bfloat16) * 0.2)(P, D) * (D ** -0.5)
        B_im = (lambda *s: torch.randn(*s, dtype=torch.bfloat16) * 0.2)(P, D) * (D ** -0.5)
        C_re = (lambda *s: torch.randn(*s, dtype=torch.bfloat16) * 0.2)(D, P) * (P ** -0.5)
        C_im = (lambda *s: torch.randn(*s, dtype=torch.bfloat16) * 0.2)(D, P) * (P ** -0.5)
        log_dt = (lambda *s: torch.randn(*s, dtype=torch.bfloat16) * 0.2)(P) * 0.3 - 2.0
        Dskip = (lambda *s: torch.randn(*s, dtype=torch.bfloat16) * 0.05)(D)
        return {
            "x": _w((lambda *s: torch.randn(*s, dtype=torch.bfloat16) * 0.05)(B, S, D)),
            "Lambda_re": _w(Lambda_re),
            "Lambda_im": _w(Lambda_im),
            "B_re": _w(B_re),
            "B_im": _w(B_im),
            "C_re": _w(C_re),
            "C_im": _w(C_im),
            "log_dt": _w(log_dt),
            "Dskip": _w(Dskip),
        }
    _A_in = _A_setup()

    def _B_setup():
        B, S, D, H = 1, 2048, 512, 32
        Dh = D // H
        return {
            "x": _w((lambda *s: torch.randn(*s, dtype=torch.bfloat16) * 0.05)(B, S, D)),
            "wq": _w((lambda *s: torch.randn(*s, dtype=torch.bfloat16) * 0.8)(D, H * Dh)),
            "wk": _w((lambda *s: torch.randn(*s, dtype=torch.bfloat16) * 0.8)(D, Dh)),
            "wv": _w((lambda *s: torch.randn(*s, dtype=torch.bfloat16) * 0.05)(D, Dh)),
            "wo": _w((lambda *s: torch.randn(*s, dtype=torch.bfloat16) * 0.05)(H * Dh, D)),
        }
    _B_in = _B_setup()

    return {
        "A_x": _A_in["x"],
        "A_Lambda_re": _A_in["Lambda_re"],
        "A_Lambda_im": _A_in["Lambda_im"],
        "A_B_re": _A_in["B_re"],
        "A_B_im": _A_in["B_im"],
        "A_C_re": _A_in["C_re"],
        "A_C_im": _A_in["C_im"],
        "A_log_dt": _A_in["log_dt"],
        "A_Dskip": _A_in["Dskip"],
        "B_x": _B_in["x"],
        "B_wq": _B_in["wq"],
        "B_wk": _B_in["wk"],
        "B_wv": _B_in["wv"],
        "B_wo": _B_in["wo"],
    }

def reference(A_x, A_Lambda_re, A_Lambda_im, A_B_re, A_B_im, A_C_re, A_C_im, A_log_dt, A_Dskip, B_x, B_wq, B_wk, B_wv, B_wo):
    def _A_ref(x, Lambda_re, Lambda_im, B_re, B_im, C_re, C_im, log_dt, Dskip):
        Bsz, L, H = x.shape
        Lam = Lambda_re + 1j * Lambda_im
        Bmat = B_re + 1j * B_im
        Cmat = C_re + 1j * C_im
        dt = torch.exp(log_dt)
        Lam_bar = torch.exp(dt * Lam)
        B_bar = ((Lam_bar - 1.0) / Lam)[:, None] * Bmat
        Bu = torch.einsum("bld,pd->blp", x + 0j, B_bar)
        h = torch.zeros_like(Bu[:, 0, :])
        hs = []
        for t in range(L):
            h = Lam_bar[None, :] * h + Bu[:, t, :]
            hs.append(h)
        hseq = torch.stack(hs, 1)
        y = 2.0 * torch.einsum("blp,dp->bld", hseq, Cmat).real + x * Dskip[None, None, :]
        return y

    def _B_ref(x, wq, wk, wv, wo):
        B, S, D = x.shape
        H = 32
        Dh = D // H
        q = (lambda x, *d: x.permute(*d))((x @ wq).reshape(B, S, H, Dh), 0, 2, 1, 3)
        k = x @ wk
        v = x @ wv
        scores = torch.einsum("bhqd,bkd->bhqk", q, k) * (Dh ** -0.5)
        p = _softmax(scores, axis=-1)
        o = torch.einsum("bhqk,bkd->bhqd", p, v)
        return (lambda x, *d: x.permute(*d))(o, 0, 2, 1, 3).reshape(B, S, H * Dh) @ wo

    a = _A_ref(A_x, A_Lambda_re, A_Lambda_im, A_B_re, A_B_im, A_C_re, A_C_im, A_log_dt, A_Dskip)
    b = _B_ref(B_x, B_wq, B_wk, B_wv, B_wo)
    return torch.concatenate([a, b], axis=-1)
```

```asm
; @launch grid=(256,1,1) block=(512,1,1) lds=163840
.amdgcn_target "amdgcn-amd-amdhsa--gfx950"
.text
.globl concat_heads__ssm_conv_s5__grouped_kv_mqa__prompt_kernel
.p2align 8
.type concat_heads__ssm_conv_s5__grouped_kv_mqa__prompt_kernel,@function
concat_heads__ssm_conv_s5__grouped_kv_mqa__prompt_kernel:
    s_cmp_ge_u32 s2, 256
    s_cbranch_scc1 L_end
    s_load_dwordx2 s[8:9], s[0:1], 72
    s_load_dwordx2 s[16:17], s[0:1], 88
    s_load_dwordx2 s[64:65], s[0:1], 96
    s_load_dwordx2 s[12:13], s[0:1], 80
    s_load_dwordx2 s[48:49], s[0:1], 128
    s_load_dwordx4 s[56:59], s[0:1], 8
    s_load_dwordx4 s[60:63], s[0:1], 56
    v_lshrrev_b32 v5, 6, v0
    v_and_b32 v1, 63, v0
    v_readfirstlane_b32 s3, v5
    v_lshlrev_b32 v4, 4, v1
    v_bfe_u32 v3, v0, 5, 1
    v_and_b32 v2, 31, v0
    v_mov_b32 v0, 162048
    s_mov_b32 s10, 65536
    s_mov_b32 s11, 0x20000
    s_bfe_u32 s4, s2, 0x20001
    s_lshl_b32 s4, s4, 3
    s_bfe_u32 s68, s2, 0x30003
    s_add_u32 s4, s4, s68
    s_and_b32 s5, s2, 1
    s_lshl_b32 s5, s5, 2
    s_lshr_b32 s68, s2, 6
    s_add_u32 s5, s5, s68
    s_add_u32 s80, s4, s5
    s_and_b32 s80, s80, 3
    s_lshl_b32 s70, s4, 16
    s_sub_u32 s81, s3, 4
    s_cbranch_scc1 L_A0
    s_setprio 3
    v_mov_b32 v20, 0
    v_mov_b32 v21, 0
    s_lshl_b32 s68, s5, 6
    s_lshl_b32 s69, s81, 4
    s_and_b32 s69, s69, 32
    s_add_u32 s68, s68, s69
    v_add_lshl_u32 v126, s68, v2, 1
    ds_write2_b64 v0, v[20:21], v[20:21] offset0:0 offset1:1
    ds_write2_b64 v0, v[20:21], v[20:21] offset0:2 offset1:3
    s_mov_b32 s18, 16384
    s_mov_b32 s19, 0x20000
    s_lshl_b32 s69, s81, 12
    s_lshl_b32 s73, s5, 13
    s_and_b32 s73, s73, 0xc000
    s_add_u32 s73, s73, s69
    s_mul_i32 s68, s81, 4160
    s_add_u32 m0, s69, 115712
    s_bitcmp1_b32 s5, 0
    s_waitcnt lgkmcnt(0)
    s_cselect_b32 s16, s64, s16
    s_cselect_b32 s17, s65, s17
    s_add_u32 s8, s8, s70
    s_addc_u32 s9, s9, 0
    buffer_load_dwordx4 v4, s[16:19], s69 offen offset:0 lds
    buffer_load_dwordx4 v4, s[16:19], s69 offen offset:1024 lds
    buffer_load_dwordx4 v4, s[16:19], s69 offen offset:2048 lds
    buffer_load_dwordx4 v4, s[16:19], s69 offen offset:3072 lds
    s_add_u32 m0, s68, 49920
    s_load_dword s66, s[48:49], 0
    buffer_load_dwordx4 v4, s[8:11], s73 offen offset:0 lds
    s_add_u32 m0, s68, 49936
    s_nop 0
    buffer_load_dwordx4 v4, s[8:11], s73 offen offset:1024 lds
    s_add_u32 m0, s68, 49952
    s_nop 0
    buffer_load_dwordx4 v4, s[8:11], s73 offen offset:2048 lds
    s_add_u32 m0, s68, 49968
    s_nop 0
    buffer_load_dwordx4 v4, s[8:11], s73 offen offset:3072 lds
    s_barrier
    global_load_ushort v100, v126, s[56:57]
    global_load_ushort v101, v126, s[58:59]
    global_load_ushort v102, v126, s[60:61]
    global_load_ushort v103, v126, s[62:63]
    s_cmp_eq_u32 s81, 1
    s_cbranch_scc1 L_qx
    s_cmp_eq_u32 s81, 2
    s_cbranch_scc1 L_qw
    s_branch L_S1
L_A0:
    v_lshrrev_b32 v6, 4, v1
    v_and_b32 v7, 15, v1
    v_lshlrev_b32 v7, 4, v7
    v_lshl_add_u32 v117, v6, 14, v7
    s_mul_i32 s74, s3, 4160
    s_lshl_b32 s83, s3, 12
    s_mov_b32 s14, 523392
    s_mov_b32 s15, 0x20000
    v_lshrrev_b32 v6, 3, v1
    v_and_b32 v7, 7, v1
    v_bfe_u32 v10, v1, 4, 1
    v_lshlrev_b32 v10, 2, v10
    v_xor_b32 v7, v7, v10
    v_lshlrev_b32 v7, 4, v7
    v_lshl_add_u32 v119, v6, 10, v7
    s_lshl_b32 s68, s5, 7
    s_waitcnt lgkmcnt(0)
    s_add_u32 s8, s8, s70
    s_addc_u32 s9, s9, 0
    s_add_u32 s12, s12, s68
    s_addc_u32 s13, s13, 0
    s_load_dword s66, s[48:49], 0
    s_barrier
    s_add_u32 s71, s80, 0
    s_and_b32 s71, s71, 3
    s_lshl_b32 s72, s71, 8
    s_add_u32 s72, s72, s83
    s_add_u32 m0, s74, 0
    s_nop 0
    buffer_load_dwordx4 v117, s[8:11], s72 offen offset:0 lds
    s_add_u32 m0, s74, 16
    s_nop 0
    buffer_load_dwordx4 v117, s[8:11], s72 offen offset:1024 lds
    s_add_u32 m0, s74, 32
    s_nop 0
    buffer_load_dwordx4 v117, s[8:11], s72 offen offset:2048 lds
    s_add_u32 m0, s74, 48
    s_nop 0
    buffer_load_dwordx4 v117, s[8:11], s72 offen offset:3072 lds
    s_lshl_b32 s71, s71, 4
    s_add_u32 s71, s71, s3
    s_lshl_b32 s71, s71, 13
    s_lshl_b32 s70, s3, 10
    s_add_u32 m0, s70, 66560
    s_add_u32 s69, s71, 0
    buffer_load_dwordx4 v119, s[12:15], s69 offen lds
    s_add_u32 m0, s70, 70656
    s_add_u32 s69, s71, 32768
    buffer_load_dwordx4 v119, s[12:15], s69 offen lds
    s_add_u32 m0, s70, 74752
    s_add_u32 s69, s71, 65536
    buffer_load_dwordx4 v119, s[12:15], s69 offen lds
    s_add_u32 m0, s70, 78848
    s_add_u32 s69, s71, 98304
    buffer_load_dwordx4 v119, s[12:15], s69 offen lds
    s_add_u32 s71, s80, 1
    s_and_b32 s71, s71, 3
    s_lshl_b32 s72, s71, 8
    s_add_u32 s72, s72, s83
    s_add_u32 m0, s74, 16640
    s_nop 0
    buffer_load_dwordx4 v117, s[8:11], s72 offen offset:0 lds
    s_add_u32 m0, s74, 16656
    s_nop 0
    buffer_load_dwordx4 v117, s[8:11], s72 offen offset:1024 lds
    s_add_u32 m0, s74, 16672
    s_nop 0
    buffer_load_dwordx4 v117, s[8:11], s72 offen offset:2048 lds
    s_add_u32 m0, s74, 16688
    s_nop 0
    buffer_load_dwordx4 v117, s[8:11], s72 offen offset:3072 lds
    s_lshl_b32 s71, s71, 4
    s_add_u32 s71, s71, s3
    s_lshl_b32 s71, s71, 13
    s_lshl_b32 s70, s3, 10
    s_add_u32 m0, s70, 82944
    s_add_u32 s69, s71, 0
    buffer_load_dwordx4 v119, s[12:15], s69 offen lds
    s_add_u32 m0, s70, 87040
    s_add_u32 s69, s71, 32768
    buffer_load_dwordx4 v119, s[12:15], s69 offen lds
    s_add_u32 m0, s70, 91136
    s_add_u32 s69, s71, 65536
    buffer_load_dwordx4 v119, s[12:15], s69 offen lds
    s_add_u32 m0, s70, 95232
    s_add_u32 s69, s71, 98304
    buffer_load_dwordx4 v119, s[12:15], s69 offen lds
    s_branch L_A1
L_S1:
    s_cmp_lg_u32 s3, 7
    s_cbranch_scc1 L_nopfcode
    s_getpc_b64 s[68:69]
    L_pc:
    s_sub_u32 s68, s68, L_pc-concat_heads__ssm_conv_s5__grouped_kv_mqa__prompt_kernel
    s_subb_u32 s69, s69, 0
    s_lshl_b32 s78, s80, 13
    v_lshlrev_b32 v16, 7, v1
    v_add_u32 v16, s78, v16
    v_min_u32 v16, L_hot_end-concat_heads__ssm_conv_s5__grouped_kv_mqa__prompt_kernel-4, v16
    global_load_dword v127, v16, s[68:69]
    L_nopfcode:
    v_mov_b32 v124, 1
    s_lshl_b32 s7, s4, 3
    s_add_u32 s7, s7, s5
    s_mov_b32 s50, 33554432
    s_mov_b32 s51, 0x20000
    v_lshrrev_b32 v20, 4, v1
    v_and_b32 v21, 15, v1
    v_mul_u32_u24 v9, 1040, v21
    v_lshl_add_u32 v9, v20, 4, v9
    v_add_u32 v9, 49920, v9
    v_lshrrev_b32 v10, 2, v21
    v_lshl_add_u32 v10, v20, 3, v10
    v_lshlrev_b32 v10, 5, v10
    v_and_b32 v11, 3, v21
    v_lshl_add_u32 v10, v11, 3, v10
    v_add_u32 v10, 115712, v10
    s_lshl_b32 s74, s4, 1
    s_lshr_b32 s69, s5, 2
    s_add_u32 s74, s74, s69
    s_lshl_b32 s74, s74, 12
    s_add_u32 s74, s74, 524288
    s_bfe_u32 s83, s5, 0x10001
    s_waitcnt lgkmcnt(0)
    s_mul_i32 s6, s66, 0x9E3779B1
    s_add_u32 s6, s6, 0x7F4A7C15
    s_waitcnt vmcnt(4)
    s_mov_b64 exec, 1
    ds_add_u32 v0, v124 offset:0
    s_mov_b64 exec, -1
    s_cmp_lg_u32 s81, 0
    s_cbranch_scc1 L_S2a
    s_mov_b32 s75, 0
    L_sy_1:
    ds_read_b32 v125, v0 offset:0
    s_add_u32 s75, s75, 1
    s_waitcnt lgkmcnt(0)
    v_readfirstlane_b32 s68, v125
    s_cmp_ge_u32 s68, 4
    s_cbranch_scc1 L_syd_2
    s_cmp_lt_u32 s75, 200000
    s_cbranch_scc1 L_sy_1
    L_syd_2:
    ds_read_b64_tr_b16 v[32:33], v10 offset:0
    ds_read_b64_tr_b16 v[34:35], v10 offset:128
    ds_read_b128 v[36:39], v9 offset:0
    ds_read_b64_tr_b16 v[40:41], v10 offset:1024
    ds_read_b64_tr_b16 v[42:43], v10 offset:1152
    ds_read_b128 v[44:47], v9 offset:64
    ds_read_b64_tr_b16 v[48:49], v10 offset:2048
    ds_read_b64_tr_b16 v[50:51], v10 offset:2176
    ds_read_b128 v[52:55], v9 offset:128
    ds_read_b64_tr_b16 v[56:57], v10 offset:3072
    ds_read_b64_tr_b16 v[58:59], v10 offset:3200
    ds_read_b128 v[60:63], v9 offset:192
    s_bitcmp1_b32 s5, 0
    s_cbranch_scc1 L_kv_v
    ds_read_b64_tr_b16 v[64:65], v10 offset:4096
    ds_read_b64_tr_b16 v[66:67], v10 offset:4224
    ds_read_b128 v[68:71], v9 offset:256
    s_waitcnt lgkmcnt(12)
    v_mfma_f32_16x16x32_bf16 v[28:31], v[32:35], v[36:39], 0
    ds_read_b64_tr_b16 v[72:73], v10 offset:5120
    ds_read_b64_tr_b16 v[74:75], v10 offset:5248
    ds_read_b128 v[76:79], v9 offset:320
    s_waitcnt lgkmcnt(12)
    v_mfma_f32_16x16x32_bf16 v[28:31], v[40:43], v[44:47], v[28:31]
    ds_read_b64_tr_b16 v[32:33], v10 offset:6144
    ds_read_b64_tr_b16 v[34:35], v10 offset:6272
    ds_read_b128 v[36:39], v9 offset:384
    s_waitcnt lgkmcnt(12)
    v_mfma_f32_16x16x32_bf16 v[28:31], v[48:51], v[52:55], v[28:31]
    ds_read_b64_tr_b16 v[40:41], v10 offset:7168
    ds_read_b64_tr_b16 v[42:43], v10 offset:7296
    ds_read_b128 v[44:47], v9 offset:448
    s_waitcnt lgkmcnt(12)
    v_mfma_f32_16x16x32_bf16 v[28:31], v[56:59], v[60:63], v[28:31]
    ds_read_b64_tr_b16 v[48:49], v10 offset:8192
    ds_read_b64_tr_b16 v[50:51], v10 offset:8320
    ds_read_b128 v[52:55], v9 offset:512
    s_waitcnt lgkmcnt(12)
    v_mfma_f32_16x16x32_bf16 v[28:31], v[64:67], v[68:71], v[28:31]
    ds_read_b64_tr_b16 v[56:57], v10 offset:9216
    ds_read_b64_tr_b16 v[58:59], v10 offset:9344
    ds_read_b128 v[60:63], v9 offset:576
    s_waitcnt lgkmcnt(12)
    v_mfma_f32_16x16x32_bf16 v[28:31], v[72:75], v[76:79], v[28:31]
    ds_read_b64_tr_b16 v[64:65], v10 offset:10240
    ds_read_b64_tr_b16 v[66:67], v10 offset:10368
    ds_read_b128 v[68:71], v9 offset:640
    s_waitcnt lgkmcnt(12)
    v_mfma_f32_16x16x32_bf16 v[28:31], v[32:35], v[36:39], v[28:31]
    ds_read_b64_tr_b16 v[72:73], v10 offset:11264
    ds_read_b64_tr_b16 v[74:75], v10 offset:11392
    ds_read_b128 v[76:79], v9 offset:704
    s_waitcnt lgkmcnt(12)
    v_mfma_f32_16x16x32_bf16 v[28:31], v[40:43], v[44:47], v[28:31]
    ds_read_b64_tr_b16 v[32:33], v10 offset:12288
    ds_read_b64_tr_b16 v[34:35], v10 offset:12416
    ds_read_b128 v[36:39], v9 offset:768
    s_waitcnt lgkmcnt(12)
    v_mfma_f32_16x16x32_bf16 v[28:31], v[48:51], v[52:55], v[28:31]
    ds_read_b64_tr_b16 v[40:41], v10 offset:13312
    ds_read_b64_tr_b16 v[42:43], v10 offset:13440
    ds_read_b128 v[44:47], v9 offset:832
    s_waitcnt lgkmcnt(12)
    v_mfma_f32_16x16x32_bf16 v[28:31], v[56:59], v[60:63], v[28:31]
    ds_read_b64_tr_b16 v[48:49], v10 offset:14336
    ds_read_b64_tr_b16 v[50:51], v10 offset:14464
    ds_read_b128 v[52:55], v9 offset:896
    s_waitcnt lgkmcnt(12)
    v_mfma_f32_16x16x32_bf16 v[28:31], v[64:67], v[68:71], v[28:31]
    ds_read_b64_tr_b16 v[56:57], v10 offset:15360
    ds_read_b64_tr_b16 v[58:59], v10 offset:15488
    ds_read_b128 v[60:63], v9 offset:960
    s_waitcnt lgkmcnt(12)
    v_mfma_f32_16x16x32_bf16 v[28:31], v[72:75], v[76:79], v[28:31]
    s_waitcnt lgkmcnt(9)
    v_mfma_f32_16x16x32_bf16 v[28:31], v[32:35], v[36:39], v[28:31]
    s_waitcnt lgkmcnt(6)
    v_mfma_f32_16x16x32_bf16 v[28:31], v[40:43], v[44:47], v[28:31]
    s_waitcnt lgkmcnt(3)
    v_mfma_f32_16x16x32_bf16 v[28:31], v[48:51], v[52:55], v[28:31]
    s_waitcnt lgkmcnt(0)
    v_mfma_f32_16x16x32_bf16 v[28:31], v[56:59], v[60:63], v[28:31]
    s_nop 2
    s_mov_b32 s68, 1052289595
    s_lshl_b32 s83, s83, 8
    s_add_u32 s74, s74, s83
    v_and_b32 v22, 1, v20
    v_lshlrev_b32 v22, 9, v22
    v_lshl_add_u32 v22, v21, 4, v22
    v_lshrrev_b32 v23, 1, v20
    v_lshl_add_u32 v22, v23, 3, v22
    v_cvt_pk_bf16_f32 v26, v28, v29
    v_cvt_pk_bf16_f32 v27, v30, v31
    v_mul_f32 v28, s68, v28
    v_mul_f32 v29, s68, v29
    v_mul_f32 v30, s68, v30
    v_mul_f32 v31, s68, v31
    v_cvt_pk_bf16_f32 v24, v28, v29
    v_cvt_pk_bf16_f32 v25, v30, v31
    buffer_store_dwordx2 v[24:25], v22, s[48:51], s74 offen sc1
    buffer_store_dwordx2 v[26:27], v22, s[48:51], s74 offen offset:2560 sc1
    s_mov_b64 exec, 1
    ds_add_u32 v0, v124 offset:0
    s_mov_b64 exec, -1
    v_mul_f32 v16, v28, v28
    v_fmac_f32 v16, v29, v29
    v_fmac_f32 v16, v30, v30
    v_fmac_f32 v16, v31, v31
    v_mov_b32 v17, v16
    s_nop 1
    v_permlane16_swap_b32 v17, v16
    v_add_f32 v16, v16, v17
    v_mov_b32 v17, v16
    s_nop 1
    v_permlane32_swap_b32 v17, v16
    v_add_f32 v17, v16, v17
    s_nop 1
    v_max_f32_dpp v17, v17, v17 row_ror:1 row_mask:0xf bank_mask:0xf
    s_nop 1
    v_max_f32_dpp v17, v17, v17 row_ror:2 row_mask:0xf bank_mask:0xf
    s_nop 1
    v_max_f32_dpp v17, v17, v17 row_ror:4 row_mask:0xf bank_mask:0xf
    s_nop 1
    v_max_f32_dpp v17, v17, v17 row_ror:8 row_mask:0xf bank_mask:0xf
    s_nop 1
    v_mov_b32 v18, v17
    s_nop 1
    v_permlane16_swap_b32 v18, v17
    v_max_f32 v17, v17, v18
    v_mov_b32 v18, v17
    s_nop 1
    v_permlane32_swap_b32 v18, v17
    v_max_f32 v17, v17, v18
    s_branch L_kv_pub
L_kv_v:
    ds_read_b64_tr_b16 v[64:65], v10 offset:4096
    ds_read_b64_tr_b16 v[66:67], v10 offset:4224
    ds_read_b128 v[68:71], v9 offset:256
    s_waitcnt lgkmcnt(12)
    v_mfma_f32_16x16x32_bf16 v[28:31], v[36:39], v[32:35], 0
    ds_read_b64_tr_b16 v[72:73], v10 offset:5120
    ds_read_b64_tr_b16 v[74:75], v10 offset:5248
    ds_read_b128 v[76:79], v9 offset:320
    s_waitcnt lgkmcnt(12)
    v_mfma_f32_16x16x32_bf16 v[28:31], v[44:47], v[40:43], v[28:31]
    ds_read_b64_tr_b16 v[32:33], v10 offset:6144
    ds_read_b64_tr_b16 v[34:35], v10 offset:6272
    ds_read_b128 v[36:39], v9 offset:384
    s_waitcnt lgkmcnt(12)
    v_mfma_f32_16x16x32_bf16 v[28:31], v[52:55], v[48:51], v[28:31]
    ds_read_b64_tr_b16 v[40:41], v10 offset:7168
    ds_read_b64_tr_b16 v[42:43], v10 offset:7296
    ds_read_b128 v[44:47], v9 offset:448
    s_waitcnt lgkmcnt(12)
    v_mfma_f32_16x16x32_bf16 v[28:31], v[60:63], v[56:59], v[28:31]
    ds_read_b64_tr_b16 v[48:49], v10 offset:8192
    ds_read_b64_tr_b16 v[50:51], v10 offset:8320
    ds_read_b128 v[52:55], v9 offset:512
    s_waitcnt lgkmcnt(12)
    v_mfma_f32_16x16x32_bf16 v[28:31], v[68:71], v[64:67], v[28:31]
    ds_read_b64_tr_b16 v[56:57], v10 offset:9216
    ds_read_b64_tr_b16 v[58:59], v10 offset:9344
    ds_read_b128 v[60:63], v9 offset:576
    s_waitcnt lgkmcnt(12)
    v_mfma_f32_16x16x32_bf16 v[28:31], v[76:79], v[72:75], v[28:31]
    ds_read_b64_tr_b16 v[64:65], v10 offset:10240
    ds_read_b64_tr_b16 v[66:67], v10 offset:10368
    ds_read_b128 v[68:71], v9 offset:640
    s_waitcnt lgkmcnt(12)
    v_mfma_f32_16x16x32_bf16 v[28:31], v[36:39], v[32:35], v[28:31]
    ds_read_b64_tr_b16 v[72:73], v10 offset:11264
    ds_read_b64_tr_b16 v[74:75], v10 offset:11392
    ds_read_b128 v[76:79], v9 offset:704
    s_waitcnt lgkmcnt(12)
    v_mfma_f32_16x16x32_bf16 v[28:31], v[44:47], v[40:43], v[28:31]
    ds_read_b64_tr_b16 v[32:33], v10 offset:12288
    ds_read_b64_tr_b16 v[34:35], v10 offset:12416
    ds_read_b128 v[36:39], v9 offset:768
    s_waitcnt lgkmcnt(12)
    v_mfma_f32_16x16x32_bf16 v[28:31], v[52:55], v[48:51], v[28:31]
    ds_read_b64_tr_b16 v[40:41], v10 offset:13312
    ds_read_b64_tr_b16 v[42:43], v10 offset:13440
    ds_read_b128 v[44:47], v9 offset:832
    s_waitcnt lgkmcnt(12)
    v_mfma_f32_16x16x32_bf16 v[28:31], v[60:63], v[56:59], v[28:31]
    ds_read_b64_tr_b16 v[48:49], v10 offset:14336
    ds_read_b64_tr_b16 v[50:51], v10 offset:14464
    ds_read_b128 v[52:55], v9 offset:896
    s_waitcnt lgkmcnt(12)
    v_mfma_f32_16x16x32_bf16 v[28:31], v[68:71], v[64:67], v[28:31]
    ds_read_b64_tr_b16 v[56:57], v10 offset:15360
    ds_read_b64_tr_b16 v[58:59], v10 offset:15488
    ds_read_b128 v[60:63], v9 offset:960
    s_waitcnt lgkmcnt(12)
    v_mfma_f32_16x16x32_bf16 v[28:31], v[76:79], v[72:75], v[28:31]
    s_waitcnt lgkmcnt(9)
    v_mfma_f32_16x16x32_bf16 v[28:31], v[36:39], v[32:35], v[28:31]
    s_waitcnt lgkmcnt(6)
    v_mfma_f32_16x16x32_bf16 v[28:31], v[44:47], v[40:43], v[28:31]
    s_waitcnt lgkmcnt(3)
    v_mfma_f32_16x16x32_bf16 v[28:31], v[52:55], v[48:51], v[28:31]
    s_waitcnt lgkmcnt(0)
    v_mfma_f32_16x16x32_bf16 v[28:31], v[60:63], v[56:59], v[28:31]
    s_mul_i32 s83, s83, 544
    s_add_u32 s74, s74, s83
    s_add_u32 s74, s74, 1024
    v_lshrrev_b32 v22, 1, v20
    v_mul_u32_u24 v22, 272, v22
    v_and_b32 v23, 1, v20
    v_lshl_add_u32 v22, v23, 3, v22
    v_lshl_add_u32 v23, v21, 4, v22
    v_cvt_pk_bf16_f32 v24, v28, v29
    v_cvt_pk_bf16_f32 v25, v30, v31
    buffer_store_dwordx2 v[24:25], v23, s[48:51], s74 offen sc1
    v_mov_b32 v26, 0x3f803f80
    v_mov_b32 v27, 0x3f803f80
    s_mov_b32 exec_lo, 0x00010001
    s_mov_b32 exec_hi, 0x00010001
    buffer_store_dwordx2 v[26:27], v22, s[48:51], s74 offen offset:256 sc1
    s_mov_b64 exec, -1
    v_mov_b32 v17, 0
    s_mov_b64 exec, 1
    ds_add_u32 v0, v124 offset:0
    s_mov_b64 exec, -1
L_kv_pub:
    s_lshl_b32 s68, s7, 7
    s_add_u32 s68, s68, 4096
    v_mov_b32 v16, s6
    v_mov_b32 v9, 0
    s_waitcnt vmcnt(0)
    s_mov_b64 exec, 1
    buffer_store_dwordx2 v[16:17], v9, s[48:51], s68 offen sc1
    ds_add_u32 v0, v124
    s_mov_b64 exec, -1
    s_branch L_S2
L_qx:
    v_lshrrev_b32 v20, 4, v1
    v_and_b32 v21, 15, v1
    v_lshlrev_b32 v22, 4, v21
    v_lshl_add_u32 v22, v20, 14, v22
    v_mov_b32 v124, 1
    s_lshl_b32 s7, s4, 3
    s_add_u32 s7, s7, s5
    s_waitcnt lgkmcnt(0)
    s_mul_i32 s6, s66, 0x9E3779B1
    s_add_u32 s6, s6, 0x7F4A7C15
    s_waitcnt vmcnt(4)
    s_mov_b64 exec, 1
    ds_add_u32 v0, v124 offset:0
    s_mov_b64 exec, -1
    s_setprio 0
    s_mov_b32 s75, 0
    L_sy_3:
    ds_read_b32 v125, v0 offset:0
    s_add_u32 s75, s75, 1
    s_waitcnt lgkmcnt(0)
    v_readfirstlane_b32 s68, v125
    s_cmp_ge_u32 s68, 5
    s_cbranch_scc1 L_syd_4
    s_cmp_lt_u32 s75, 200000
    s_cbranch_scc1 L_sy_3
    L_syd_4:
    s_add_u32 s71, s80, 2
    s_and_b32 s71, s71, 3
    s_lshl_b32 s71, s71, 8
    s_mov_b32 m0, 33280
    s_nop 0
    buffer_load_dwordx4 v22, s[8:11], s71 offen offset:0 lds
    s_mov_b32 m0, 33296
    s_nop 0
    buffer_load_dwordx4 v22, s[8:11], s71 offen offset:1024 lds
    s_mov_b32 m0, 33312
    s_nop 0
    buffer_load_dwordx4 v22, s[8:11], s71 offen offset:2048 lds
    s_mov_b32 m0, 33328
    s_nop 0
    buffer_load_dwordx4 v22, s[8:11], s71 offen offset:3072 lds
    s_mov_b32 m0, 37440
    s_add_u32 s71, s71, 4096
    buffer_load_dwordx4 v22, s[8:11], s71 offen offset:0 lds
    s_mov_b32 m0, 37456
    s_nop 0
    buffer_load_dwordx4 v22, s[8:11], s71 offen offset:1024 lds
    s_mov_b32 m0, 37472
    s_nop 0
    buffer_load_dwordx4 v22, s[8:11], s71 offen offset:2048 lds
    s_mov_b32 m0, 37488
    s_nop 0
    buffer_load_dwordx4 v22, s[8:11], s71 offen offset:3072 lds
    s_mov_b32 m0, 41600
    s_add_u32 s71, s71, 4096
    buffer_load_dwordx4 v22, s[8:11], s71 offen offset:0 lds
    s_mov_b32 m0, 41616
    s_nop 0
    buffer_load_dwordx4 v22, s[8:11], s71 offen offset:1024 lds
    s_mov_b32 m0, 41632
    s_nop 0
    buffer_load_dwordx4 v22, s[8:11], s71 offen offset:2048 lds
    s_mov_b32 m0, 41648
    s_nop 0
    buffer_load_dwordx4 v22, s[8:11], s71 offen offset:3072 lds
    s_mov_b32 m0, 45760
    s_add_u32 s71, s71, 4096
    buffer_load_dwordx4 v22, s[8:11], s71 offen offset:0 lds
    s_mov_b32 m0, 45776
    s_nop 0
    buffer_load_dwordx4 v22, s[8:11], s71 offen offset:1024 lds
    s_mov_b32 m0, 45792
    s_nop 0
    buffer_load_dwordx4 v22, s[8:11], s71 offen offset:2048 lds
    s_mov_b32 m0, 45808
    s_nop 0
    buffer_load_dwordx4 v22, s[8:11], s71 offen offset:3072 lds
    s_add_u32 s71, s80, 3
    s_and_b32 s71, s71, 3
    s_lshl_b32 s71, s71, 8
    s_mov_b32 m0, 49920
    s_nop 0
    buffer_load_dwordx4 v22, s[8:11], s71 offen offset:0 lds
    s_mov_b32 m0, 49936
    s_nop 0
    buffer_load_dwordx4 v22, s[8:11], s71 offen offset:1024 lds
    s_mov_b32 m0, 49952
    s_nop 0
    buffer_load_dwordx4 v22, s[8:11], s71 offen offset:2048 lds
    s_mov_b32 m0, 49968
    s_nop 0
    buffer_load_dwordx4 v22, s[8:11], s71 offen offset:3072 lds
    s_mov_b32 m0, 54080
    s_add_u32 s71, s71, 4096
    buffer_load_dwordx4 v22, s[8:11], s71 offen offset:0 lds
    s_mov_b32 m0, 54096
    s_nop 0
    buffer_load_dwordx4 v22, s[8:11], s71 offen offset:1024 lds
    s_mov_b32 m0, 54112
    s_nop 0
    buffer_load_dwordx4 v22, s[8:11], s71 offen offset:2048 lds
    s_mov_b32 m0, 54128
    s_nop 0
    buffer_load_dwordx4 v22, s[8:11], s71 offen offset:3072 lds
    s_mov_b32 m0, 58240
    s_add_u32 s71, s71, 4096
    buffer_load_dwordx4 v22, s[8:11], s71 offen offset:0 lds
    s_mov_b32 m0, 58256
    s_nop 0
    buffer_load_dwordx4 v22, s[8:11], s71 offen offset:1024 lds
    s_mov_b32 m0, 58272
    s_nop 0
    buffer_load_dwordx4 v22, s[8:11], s71 offen offset:2048 lds
    s_mov_b32 m0, 58288
    s_nop 0
    buffer_load_dwordx4 v22, s[8:11], s71 offen offset:3072 lds
    s_mov_b32 m0, 62400
    s_add_u32 s71, s71, 4096
    buffer_load_dwordx4 v22, s[8:11], s71 offen offset:0 lds
    s_mov_b32 m0, 62416
    s_nop 0
    buffer_load_dwordx4 v22, s[8:11], s71 offen offset:1024 lds
    s_mov_b32 m0, 62432
    s_nop 0
    buffer_load_dwordx4 v22, s[8:11], s71 offen offset:2048 lds
    s_mov_b32 m0, 62448
    s_nop 0
    buffer_load_dwordx4 v22, s[8:11], s71 offen offset:3072 lds
    s_waitcnt vmcnt(16)
    s_mov_b64 exec, 1
    ds_add_u32 v0, v124 offset:24
    s_mov_b64 exec, -1
    s_waitcnt vmcnt(0)
    s_mov_b64 exec, 1
    ds_add_u32 v0, v124 offset:28
    s_mov_b64 exec, -1
    s_setprio 3
    s_branch L_S2
L_qw:
    s_mov_b32 s14, 523392
    s_mov_b32 s15, 0x20000
    v_lshrrev_b32 v23, 3, v1
    v_and_b32 v24, 7, v1
    v_bfe_u32 v25, v1, 4, 1
    v_lshlrev_b32 v25, 2, v25
    v_xor_b32 v24, v24, v25
    v_lshlrev_b32 v24, 4, v24
    v_lshl_add_u32 v22, v23, 10, v24
    s_lshl_b32 s68, s5, 7
    s_add_u32 s12, s12, s68
    s_addc_u32 s13, s13, 0
    v_mov_b32 v124, 1
    s_lshl_b32 s7, s4, 3
    s_add_u32 s7, s7, s5
    s_waitcnt lgkmcnt(0)
    s_mul_i32 s6, s66, 0x9E3779B1
    s_add_u32 s6, s6, 0x7F4A7C15
    s_waitcnt vmcnt(4)
    s_mov_b64 exec, 1
    ds_add_u32 v0, v124 offset:0
    s_mov_b64 exec, -1
    s_setprio 0
    s_mov_b32 s75, 0
    L_sy_5:
    ds_read_b32 v125, v0 offset:0
    s_add_u32 s75, s75, 1
    s_waitcnt lgkmcnt(0)
    v_readfirstlane_b32 s68, v125
    s_cmp_ge_u32 s68, 5
    s_cbranch_scc1 L_syd_6
    s_cmp_lt_u32 s75, 200000
    s_cbranch_scc1 L_sy_5
    L_syd_6:
    s_add_u32 s71, s80, 2
    s_and_b32 s71, s71, 3
    s_lshl_b32 s71, s71, 17
    s_mov_b32 m0, 99328
    s_nop 0
    buffer_load_dwordx4 v22, s[12:15], s71 offen lds
    s_mov_b32 m0, 100352
    s_add_u32 s71, s71, 8192
    buffer_load_dwordx4 v22, s[12:15], s71 offen lds
    s_mov_b32 m0, 101376
    s_add_u32 s71, s71, 8192
    buffer_load_dwordx4 v22, s[12:15], s71 offen lds
    s_mov_b32 m0, 102400
    s_add_u32 s71, s71, 8192
    buffer_load_dwordx4 v22, s[12:15], s71 offen lds
    s_mov_b32 m0, 103424
    s_add_u32 s71, s71, 8192
    buffer_load_dwordx4 v22, s[12:15], s71 offen lds
    s_mov_b32 m0, 104448
    s_add_u32 s71, s71, 8192
    buffer_load_dwordx4 v22, s[12:15], s71 offen lds
    s_mov_b32 m0, 105472
    s_add_u32 s71, s71, 8192
    buffer_load_dwordx4 v22, s[12:15], s71 offen lds
    s_mov_b32 m0, 106496
    s_add_u32 s71, s71, 8192
    buffer_load_dwordx4 v22, s[12:15], s71 offen lds
    s_mov_b32 m0, 107520
    s_add_u32 s71, s71, 8192
    buffer_load_dwordx4 v22, s[12:15], s71 offen lds
    s_mov_b32 m0, 108544
    s_add_u32 s71, s71, 8192
    buffer_load_dwordx4 v22, s[12:15], s71 offen lds
    s_mov_b32 m0, 109568
    s_add_u32 s71, s71, 8192
    buffer_load_dwordx4 v22, s[12:15], s71 offen lds
    s_mov_b32 m0, 110592
    s_add_u32 s71, s71, 8192
    buffer_load_dwordx4 v22, s[12:15], s71 offen lds
    s_mov_b32 m0, 111616
    s_add_u32 s71, s71, 8192
    buffer_load_dwordx4 v22, s[12:15], s71 offen lds
    s_mov_b32 m0, 112640
    s_add_u32 s71, s71, 8192
    buffer_load_dwordx4 v22, s[12:15], s71 offen lds
    s_mov_b32 m0, 113664
    s_add_u32 s71, s71, 8192
    buffer_load_dwordx4 v22, s[12:15], s71 offen lds
    s_mov_b32 m0, 114688
    s_add_u32 s71, s71, 8192
    buffer_load_dwordx4 v22, s[12:15], s71 offen lds
    s_add_u32 s71, s80, 3
    s_and_b32 s71, s71, 3
    s_lshl_b32 s71, s71, 17
    s_mov_b32 m0, 115712
    s_nop 0
    buffer_load_dwordx4 v22, s[12:15], s71 offen lds
    s_mov_b32 m0, 116736
    s_add_u32 s71, s71, 8192
    buffer_load_dwordx4 v22, s[12:15], s71 offen lds
    s_mov_b32 m0, 117760
    s_add_u32 s71, s71, 8192
    buffer_load_dwordx4 v22, s[12:15], s71 offen lds
    s_mov_b32 m0, 118784
    s_add_u32 s71, s71, 8192
    buffer_load_dwordx4 v22, s[12:15], s71 offen lds
    s_mov_b32 m0, 119808
    s_add_u32 s71, s71, 8192
    buffer_load_dwordx4 v22, s[12:15], s71 offen lds
    s_mov_b32 m0, 120832
    s_add_u32 s71, s71, 8192
    buffer_load_dwordx4 v22, s[12:15], s71 offen lds
    s_mov_b32 m0, 121856
    s_add_u32 s71, s71, 8192
    buffer_load_dwordx4 v22, s[12:15], s71 offen lds
    s_mov_b32 m0, 122880
    s_add_u32 s71, s71, 8192
    buffer_load_dwordx4 v22, s[12:15], s71 offen lds
    s_mov_b32 m0, 123904
    s_add_u32 s71, s71, 8192
    buffer_load_dwordx4 v22, s[12:15], s71 offen lds
    s_mov_b32 m0, 124928
    s_add_u32 s71, s71, 8192
    buffer_load_dwordx4 v22, s[12:15], s71 offen lds
    s_mov_b32 m0, 125952
    s_add_u32 s71, s71, 8192
    buffer_load_dwordx4 v22, s[12:15], s71 offen lds
    s_mov_b32 m0, 126976
    s_add_u32 s71, s71, 8192
    buffer_load_dwordx4 v22, s[12:15], s71 offen lds
    s_mov_b32 m0, 128000
    s_add_u32 s71, s71, 8192
    buffer_load_dwordx4 v22, s[12:15], s71 offen lds
    s_mov_b32 m0, 129024
    s_add_u32 s71, s71, 8192
    buffer_load_dwordx4 v22, s[12:15], s71 offen lds
    s_mov_b32 m0, 130048
    s_add_u32 s71, s71, 8192
    buffer_load_dwordx4 v22, s[12:15], s71 offen lds
    s_mov_b32 m0, 131072
    s_add_u32 s71, s71, 8192
    buffer_load_dwordx4 v22, s[12:15], s71 offen lds
    s_waitcnt vmcnt(16)
    s_mov_b64 exec, 1
    ds_add_u32 v0, v124 offset:24
    s_mov_b64 exec, -1
    s_waitcnt vmcnt(0)
    s_mov_b64 exec, 1
    ds_add_u32 v0, v124 offset:28
    s_mov_b64 exec, -1
    s_setprio 3
    s_branch L_S2
L_A1:
    v_mov_b32 v120, 0
    v_mov_b32 v121, 0
    v_mov_b32 v122, 0
    v_mov_b32 v123, 0
    s_load_dwordx2 s[44:45], s[0:1], 112
    s_mov_b32 s50, 33554432
    s_mov_b32 s51, 0x20000
    s_mov_b32 s46, 262144
    s_mov_b32 s47, 0x20000
    s_and_b32 s76, s3, 1
    s_bfe_u32 s77, s3, 0x10001
    s_lshl_b32 s7, s4, 3
    s_add_u32 s7, s7, s5
    s_mov_b32 s67, 0
    s_lshl_b32 s82, s4, 1
    s_add_u32 s82, s82, s76
    s_lshl_b32 s82, s82, 15
    s_add_u32 s82, s82, 1048576
    v_mfma_f32_32x32x16_bf16 a[0:15], v[120:123], v[120:123], 0
    v_mfma_f32_32x32x16_bf16 a[16:31], v[120:123], v[120:123], 0
    v_mfma_f32_32x32x16_bf16 a[32:47], v[120:123], v[120:123], 0
    v_mfma_f32_32x32x16_bf16 a[48:63], v[120:123], v[120:123], 0
    v_mfma_f32_32x32x16_bf16 a[64:79], v[120:123], v[120:123], 0
    v_mfma_f32_32x32x16_bf16 a[80:95], v[120:123], v[120:123], 0
    v_mfma_f32_32x32x16_bf16 a[96:111], v[120:123], v[120:123], 0
    v_mfma_f32_32x32x16_bf16 a[112:127], v[120:123], v[120:123], 0
    v_and_b32 v6, 15, v2
    v_mul_u32_u24 v8, 1040, v6
    v_lshl_add_u32 v8, v3, 4, v8
    v_lshrrev_b32 v6, 4, v2
    v_lshl_add_u32 v8, v6, 8, v8
    s_lshl_b32 s68, s76, 9
    v_add_u32 v8, s68, v8
    v_bfe_u32 v6, v1, 2, 2
    v_lshl_add_u32 v6, v3, 3, v6
    v_bfe_u32 v7, v1, 4, 1
    v_and_b32 v11, 3, v1
    v_lshlrev_b32 v11, 3, v11
    v_lshl_add_u32 v11, v7, 5, v11
    s_lshl_b32 s68, s77, 6
    v_add_u32 v11, s68, v11
    v_bfe_u32 v7, v1, 3, 1
    v_lshlrev_b32 v7, 6, v7
    v_xor_b32 v11, v11, v7
    v_lshl_add_u32 v9, v6, 7, v11
    v_add_u32 v9, 66560, v9
    s_lshl_b32 s68, s3, 13
    s_add_u32 s68, s68, 4096
    v_lshlrev_b32 v10, 7, v1
    v_add_u32 v10, s68, v10
    s_lshl_b32 s68, s3, 16
    s_add_u32 s69, s68, 524288
    v_add_u32 v5, s69, v4
    s_add_u32 s69, s69, 1024
    v_lshlrev_b32 v13, 4, v2
    v_mul_u32_u24 v14, 272, v3
    v_add3_u32 v13, v13, v14, s69
    v_cmp_lt_u32 vcc, 16, v2
    v_mov_b32 v14, 0x7ff00000
    v_mov_b32 v7, 0xdddddddd
    v_cndmask_b32 v6, v13, v14, vcc
    s_lshl_b32 s79, s80, 14
    s_lshl_b32 s68, s77, 2
    s_add_u32 s68, s68, s76
    s_lshl_b32 s68, s68, 10
    s_add_u32 s68, s68, 149760
    v_add_u32 v14, s68, v4
    v_add_u32 v15, 149760, v4
    s_waitcnt lgkmcnt(0)
    s_lshl_b32 s68, s4, 18
    s_add_u32 s44, s44, s68
    s_addc_u32 s45, s45, 0
    s_mul_i32 s6, s66, 0x9E3779B1
    s_add_u32 s6, s6, 0x7F4A7C15
    s_mov_b32 s65, 0
    s_waitcnt vmcnt(8)
    s_mov_b64 exec, 1
    ds_inc_u32 v0, v7 offset:4
    s_mov_b64 exec, -1
    s_mov_b32 s75, 0
    L_sy_7:
    ds_read_b32 v11, v0 offset:4
    s_add_u32 s75, s75, 1
    s_waitcnt lgkmcnt(0)
    v_readfirstlane_b32 s68, v11
    s_cmp_ge_u32 s68, 4
    s_cbranch_scc1 L_syd_8
    s_cmp_lt_u32 s75, 200000
    s_cbranch_scc1 L_sy_7
    L_syd_8:
    ds_read_b64_tr_b16 v[32:33], v9 offset:0
    ds_read_b64_tr_b16 v[34:35], v9 offset:512
    ds_read_b128 v[36:39], v8 offset:0
    ds_read_b64_tr_b16 v[40:41], v9 offset:2048
    ds_read_b64_tr_b16 v[42:43], v9 offset:2560
    ds_read_b128 v[44:47], v8 offset:32
    ds_read_b64_tr_b16 v[48:49], v9 offset:4096
    ds_read_b64_tr_b16 v[50:51], v9 offset:4608
    ds_read_b128 v[52:55], v8 offset:64
    ds_read_b64_tr_b16 v[56:57], v9 offset:6144
    ds_read_b64_tr_b16 v[58:59], v9 offset:6656
    ds_read_b128 v[60:63], v8 offset:96
    ds_read_b64_tr_b16 v[64:65], v9 offset:8192
    ds_read_b64_tr_b16 v[66:67], v9 offset:8704
    ds_read_b128 v[68:71], v8 offset:128
    s_waitcnt lgkmcnt(12)
    v_mfma_f32_32x32x16_bf16 v[16:31], v[32:35], v[36:39], 0
    ds_read_b64_tr_b16 v[72:73], v9 offset:10240
    ds_read_b64_tr_b16 v[74:75], v9 offset:10752
    ds_read_b128 v[76:79], v8 offset:160
    s_waitcnt lgkmcnt(12)
    v_mfma_f32_32x32x16_bf16 v[16:31], v[40:43], v[44:47], v[16:31]
    s_waitcnt vmcnt(0)
    s_mov_b64 exec, 1
    ds_inc_u32 v0, v7 offset:4
    s_mov_b64 exec, -1
    ds_read_b64_tr_b16 v[32:33], v9 offset:12288
    ds_read_b64_tr_b16 v[34:35], v9 offset:12800
    ds_read_b128 v[36:39], v8 offset:192
    s_waitcnt lgkmcnt(12)
    v_mfma_f32_32x32x16_bf16 v[16:31], v[48:51], v[52:55], v[16:31]
    ds_read_b64_tr_b16 v[40:41], v9 offset:14336
    ds_read_b64_tr_b16 v[42:43], v9 offset:14848
    ds_read_b128 v[44:47], v8 offset:224
    s_waitcnt lgkmcnt(12)
    v_mfma_f32_32x32x16_bf16 v[16:31], v[56:59], v[60:63], v[16:31]
    s_mov_b32 s75, 0
    L_sy_9:
    ds_read_b32 v11, v0 offset:4
    s_add_u32 s75, s75, 1
    s_waitcnt lgkmcnt(0)
    v_readfirstlane_b32 s68, v11
    s_cmp_ge_u32 s68, 8
    s_cbranch_scc1 L_syd_10
    s_cmp_lt_u32 s75, 200000
    s_cbranch_scc1 L_sy_9
    L_syd_10:
    ds_read_b64_tr_b16 v[48:49], v9 offset:16384
    ds_read_b64_tr_b16 v[50:51], v9 offset:16896
    ds_read_b128 v[52:55], v8 offset:16640
    v_mfma_f32_32x32x16_bf16 v[16:31], v[64:67], v[68:71], v[16:31]
    ds_read_b64_tr_b16 v[56:57], v9 offset:18432
    ds_read_b64_tr_b16 v[58:59], v9 offset:18944
    ds_read_b128 v[60:63], v8 offset:16672
    v_mfma_f32_32x32x16_bf16 v[16:31], v[72:75], v[76:79], v[16:31]
    ds_read_b64_tr_b16 v[64:65], v9 offset:20480
    ds_read_b64_tr_b16 v[66:67], v9 offset:20992
    ds_read_b128 v[68:71], v8 offset:16704
    v_mfma_f32_32x32x16_bf16 v[16:31], v[32:35], v[36:39], v[16:31]
    ds_read_b64_tr_b16 v[72:73], v9 offset:22528
    ds_read_b64_tr_b16 v[74:75], v9 offset:23040
    ds_read_b128 v[76:79], v8 offset:16736
    v_mfma_f32_32x32x16_bf16 v[16:31], v[40:43], v[44:47], v[16:31]
    ds_read_b64_tr_b16 v[32:33], v9 offset:24576
    ds_read_b64_tr_b16 v[34:35], v9 offset:25088
    ds_read_b128 v[36:39], v8 offset:16768
    s_waitcnt lgkmcnt(12)
    v_mfma_f32_32x32x16_bf16 v[16:31], v[48:51], v[52:55], v[16:31]
    ds_read_b64_tr_b16 v[40:41], v9 offset:26624
    ds_read_b64_tr_b16 v[42:43], v9 offset:27136
    ds_read_b128 v[44:47], v8 offset:16800
    s_waitcnt lgkmcnt(12)
    v_mfma_f32_32x32x16_bf16 v[16:31], v[56:59], v[60:63], v[16:31]
    ds_read_b64_tr_b16 v[48:49], v9 offset:28672
    ds_read_b64_tr_b16 v[50:51], v9 offset:29184
    ds_read_b128 v[52:55], v8 offset:16832
    s_waitcnt lgkmcnt(12)
    v_mfma_f32_32x32x16_bf16 v[16:31], v[64:67], v[68:71], v[16:31]
    ds_read_b64_tr_b16 v[56:57], v9 offset:30720
    ds_read_b64_tr_b16 v[58:59], v9 offset:31232
    ds_read_b128 v[60:63], v8 offset:16864
    s_waitcnt lgkmcnt(12)
    v_mfma_f32_32x32x16_bf16 v[16:31], v[72:75], v[76:79], v[16:31]
    s_mov_b32 s75, 0
    L_sy_11:
    ds_read_b32 v11, v0 offset:24
    s_add_u32 s75, s75, 1
    s_waitcnt lgkmcnt(0)
    v_readfirstlane_b32 s68, v11
    s_cmp_ge_u32 s68, 2
    s_cbranch_scc1 L_syd_12
    s_cmp_lt_u32 s75, 200000
    s_cbranch_scc1 L_sy_11
    L_syd_12:
    ds_read_b64_tr_b16 v[64:65], v9 offset:32768
    ds_read_b64_tr_b16 v[66:67], v9 offset:33280
    ds_read_b128 v[68:71], v8 offset:33280
    v_mfma_f32_32x32x16_bf16 v[16:31], v[32:35], v[36:39], v[16:31]
    ds_read_b64_tr_b16 v[72:73], v9 offset:34816
    ds_read_b64_tr_b16 v[74:75], v9 offset:35328
    ds_read_b128 v[76:79], v8 offset:33312
    v_mfma_f32_32x32x16_bf16 v[16:31], v[40:43], v[44:47], v[16:31]
    ds_read_b64_tr_b16 v[32:33], v9 offset:36864
    ds_read_b64_tr_b16 v[34:35], v9 offset:37376
    ds_read_b128 v[36:39], v8 offset:33344
    v_mfma_f32_32x32x16_bf16 v[16:31], v[48:51], v[52:55], v[16:31]
    ds_read_b64_tr_b16 v[40:41], v9 offset:38912
    ds_read_b64_tr_b16 v[42:43], v9 offset:39424
    ds_read_b128 v[44:47], v8 offset:33376
    v_mfma_f32_32x32x16_bf16 v[16:31], v[56:59], v[60:63], v[16:31]
    ds_read_b64_tr_b16 v[48:49], v9 offset:40960
    ds_read_b64_tr_b16 v[50:51], v9 offset:41472
    ds_read_b128 v[52:55], v8 offset:33408
    s_waitcnt lgkmcnt(12)
    v_mfma_f32_32x32x16_bf16 v[16:31], v[64:67], v[68:71], v[16:31]
    ds_read_b64_tr_b16 v[56:57], v9 offset:43008
    ds_read_b64_tr_b16 v[58:59], v9 offset:43520
    ds_read_b128 v[60:63], v8 offset:33440
    s_waitcnt lgkmcnt(12)
    v_mfma_f32_32x32x16_bf16 v[16:31], v[72:75], v[76:79], v[16:31]
    ds_read_b64_tr_b16 v[64:65], v9 offset:45056
    ds_read_b64_tr_b16 v[66:67], v9 offset:45568
    ds_read_b128 v[68:71], v8 offset:33472
    s_waitcnt lgkmcnt(12)
    v_mfma_f32_32x32x16_bf16 v[16:31], v[32:35], v[36:39], v[16:31]
    ds_read_b64_tr_b16 v[72:73], v9 offset:47104
    ds_read_b64_tr_b16 v[74:75], v9 offset:47616
    ds_read_b128 v[76:79], v8 offset:33504
    s_waitcnt lgkmcnt(12)
    v_mfma_f32_32x32x16_bf16 v[16:31], v[40:43], v[44:47], v[16:31]
    buffer_load_dwordx2 v[12:13], v10, s[48:51], 0 offen sc1
    s_mov_b32 s75, 0
    L_sy_13:
    ds_read_b32 v11, v0 offset:28
    s_add_u32 s75, s75, 1
    s_waitcnt lgkmcnt(0)
    v_readfirstlane_b32 s68, v11
    s_cmp_ge_u32 s68, 2
    s_cbranch_scc1 L_syd_14
    s_cmp_lt_u32 s75, 200000
    s_cbranch_scc1 L_sy_13
    L_syd_14:
    ds_read_b64_tr_b16 v[32:33], v9 offset:49152
    ds_read_b64_tr_b16 v[34:35], v9 offset:49664
    ds_read_b128 v[36:39], v8 offset:49920
    v_mfma_f32_32x32x16_bf16 v[16:31], v[48:51], v[52:55], v[16:31]
    ds_read_b64_tr_b16 v[40:41], v9 offset:51200
    ds_read_b64_tr_b16 v[42:43], v9 offset:51712
    ds_read_b128 v[44:47], v8 offset:49952
    v_mfma_f32_32x32x16_bf16 v[16:31], v[56:59], v[60:63], v[16:31]
    ds_read_b64_tr_b16 v[48:49], v9 offset:53248
    ds_read_b64_tr_b16 v[50:51], v9 offset:53760
    ds_read_b128 v[52:55], v8 offset:49984
    v_mfma_f32_32x32x16_bf16 v[16:31], v[64:67], v[68:71], v[16:31]
    ds_read_b64_tr_b16 v[56:57], v9 offset:55296
    ds_read_b64_tr_b16 v[58:59], v9 offset:55808
    ds_read_b128 v[60:63], v8 offset:50016
    v_mfma_f32_32x32x16_bf16 v[16:31], v[72:75], v[76:79], v[16:31]
    ds_read_b64_tr_b16 v[64:65], v9 offset:57344
    ds_read_b64_tr_b16 v[66:67], v9 offset:57856
    ds_read_b128 v[68:71], v8 offset:50048
    s_waitcnt lgkmcnt(12)
    v_mfma_f32_32x32x16_bf16 v[16:31], v[32:35], v[36:39], v[16:31]
    ds_read_b64_tr_b16 v[72:73], v9 offset:59392
    ds_read_b64_tr_b16 v[74:75], v9 offset:59904
    ds_read_b128 v[76:79], v8 offset:50080
    s_waitcnt lgkmcnt(12)
    v_mfma_f32_32x32x16_bf16 v[16:31], v[40:43], v[44:47], v[16:31]
    ds_read_b64_tr_b16 v[32:33], v9 offset:61440
    ds_read_b64_tr_b16 v[34:35], v9 offset:61952
    ds_read_b128 v[36:39], v8 offset:50112
    s_waitcnt lgkmcnt(12)
    v_mfma_f32_32x32x16_bf16 v[16:31], v[48:51], v[52:55], v[16:31]
    ds_read_b64_tr_b16 v[40:41], v9 offset:63488
    ds_read_b64_tr_b16 v[42:43], v9 offset:64000
    ds_read_b128 v[44:47], v8 offset:50144
    s_waitcnt lgkmcnt(12)
    v_mfma_f32_32x32x16_bf16 v[16:31], v[56:59], v[60:63], v[16:31]
    s_waitcnt lgkmcnt(9)
    v_mfma_f32_32x32x16_bf16 v[16:31], v[64:67], v[68:71], v[16:31]
    s_waitcnt lgkmcnt(6)
    v_mfma_f32_32x32x16_bf16 v[16:31], v[72:75], v[76:79], v[16:31]
    s_waitcnt lgkmcnt(3)
    v_mfma_f32_32x32x16_bf16 v[16:31], v[32:35], v[36:39], v[16:31]
    s_waitcnt lgkmcnt(0)
    v_mfma_f32_32x32x16_bf16 v[16:31], v[40:43], v[44:47], v[16:31]
    s_mul_i32 s74, s3, 6912
    s_add_u32 s74, s74, 105472
    v_add_u32 v11, s74, v4
    s_mov_b32 s78, 4
    s_nop 7
    v_cvt_pk_bf16_f32 v32, v16, v17
    v_cvt_pk_bf16_f32 v33, v18, v19
    v_cvt_pk_bf16_f32 v34, v20, v21
    v_cvt_pk_bf16_f32 v35, v22, v23
    ds_write_b128 v14, v[32:35]
    v_cvt_pk_bf16_f32 v36, v24, v25
    v_cvt_pk_bf16_f32 v37, v26, v27
    v_cvt_pk_bf16_f32 v38, v28, v29
    v_cvt_pk_bf16_f32 v39, v30, v31
    ds_write_b128 v14, v[36:39] offset:2048
    s_waitcnt lgkmcnt(0)
    s_mov_b64 exec, 1
    ds_inc_u32 v0, v7 offset:4
    s_mov_b64 exec, -1
    v_mul_f32 v32, v16, v16
    v_fmac_f32 v32, v17, v17
    v_fmac_f32 v32, v18, v18
    v_fmac_f32 v32, v19, v19
    v_fmac_f32 v32, v20, v20
    v_fmac_f32 v32, v21, v21
    v_fmac_f32 v32, v22, v22
    v_fmac_f32 v32, v23, v23
    v_mul_f32 v33, v24, v24
    v_fmac_f32 v33, v25, v25
    v_fmac_f32 v33, v26, v26
    v_fmac_f32 v33, v27, v27
    v_fmac_f32 v33, v28, v28
    v_fmac_f32 v33, v29, v29
    v_fmac_f32 v33, v30, v30
    v_fmac_f32 v33, v31, v31
    v_mov_b32 v34, v32
    v_mov_b32 v35, v33
    v_add_u32 v8, 4096, v5
    v_add_u32 v9, 8192, v5
    v_permlane32_swap_b32 v34, v32
    v_permlane32_swap_b32 v35, v33
    v_add_f32 v32, v32, v34
    v_add_f32 v33, v33, v35
    v_max_f32 v32, v32, v33
    v_add_u32 v14, 8192, v6
    ds_max_f32 v0, v32 offset:16
    s_add_u32 s68, s3, 1
    s_and_b32 s68, s68, 3
    s_lshl_b32 s68, s68, 11
    v_add_u32 v36, s68, v15
    s_add_u32 s68, s3, 2
    s_and_b32 s68, s68, 3
    s_lshl_b32 s68, s68, 11
    v_add_u32 v37, s68, v15
    s_add_u32 s68, s3, 3
    s_and_b32 s68, s68, 3
    s_lshl_b32 s68, s68, 11
    v_add_u32 v38, s68, v15
    s_add_u32 s68, s3, 4
    s_and_b32 s68, s68, 3
    s_lshl_b32 s68, s68, 11
    v_add_u32 v39, s68, v15
    v_add_u32 v15, 12288, v6
    s_waitcnt vmcnt(0)
    v_cmp_ne_u32 vcc, s6, v12
    s_cbranch_vccnz L_kvlateb
    s_mov_b32 s65, 1
    s_add_u32 s69, s79, 0
    buffer_load_dwordx4 v[80:83], v5, s[48:51], s69 offen sc1
    buffer_load_dwordx4 v[84:87], v6, s[48:51], s69 offen offset:0 sc1
    buffer_load_dwordx4 v[88:91], v6, s[48:51], s69 offen offset:544 sc1
    s_add_u32 s69, s79, 4096
    buffer_load_dwordx4 v[92:95], v5, s[48:51], s69 offen sc1
    buffer_load_dwordx4 v[96:99], v6, s[48:51], s69 offen offset:0 sc1
    buffer_load_dwordx4 v[100:103], v6, s[48:51], s69 offen offset:544 sc1
    s_add_u32 s69, s79, 8192
    buffer_load_dwordx4 v[104:107], v5, s[48:51], s69 offen sc1
    buffer_load_dwordx4 v[108:111], v6, s[48:51], s69 offen offset:0 sc1
    buffer_load_dwordx4 v[112:115], v6, s[48:51], s69 offen offset:544 sc1
    s_add_u32 s69, s79, 12288
    buffer_load_dwordx4 v[116:119], v5, s[48:51], s69 offen sc1
    buffer_load_dwordx4 v[120:123], v6, s[48:51], s69 offen offset:0 sc1
    buffer_load_dwordx4 v[124:127], v6, s[48:51], s69 offen offset:544 sc1
    ds_max_f32 v0, v13 offset:20
    s_mov_b64 exec, 1
    ds_inc_u32 v0, v7 offset:12
    s_mov_b64 exec, -1
    s_branch L_kvqb
L_kvlateb:
    buffer_load_dwordx2 v[12:13], v10, s[48:51], 0 offen sc1
L_kvqb:
    s_mov_b32 s75, 0
    L_sy_15:
    ds_read_b32 v35, v0 offset:4
    s_add_u32 s75, s75, 1
    s_waitcnt lgkmcnt(0)
    v_readfirstlane_b32 s68, v35
    s_cmp_ge_u32 s68, 12
    s_cbranch_scc1 L_syd_16
    s_cmp_lt_u32 s75, 200000
    s_cbranch_scc1 L_sy_15
    L_syd_16:
    ds_read_b128 v[48:51], v36
    ds_read_b128 v[52:55], v36 offset:1024
    ds_read_b128 v[56:59], v37
    ds_read_b128 v[60:63], v37 offset:1024
    ds_read_b128 v[64:67], v38
    ds_read_b128 v[68:71], v38 offset:1024
    ds_read_b128 v[72:75], v39
    ds_read_b128 v[76:79], v39 offset:1024
    s_cmp_lg_u32 s65, 0
    s_cbranch_scc1 L_kvgo
    s_waitcnt vmcnt(0)
    v_cmp_ne_u32 vcc, s6, v12
    s_cbranch_vccz L_kvok
    s_mov_b32 s75, 0
L_pl_17:
    buffer_load_dwordx2 v[12:13], v10, s[48:51], 0 offen sc1
    s_add_u32 s75, s75, 1
    s_waitcnt vmcnt(0)
    v_cmp_ne_u32 vcc, s6, v12
    s_cbranch_vccz L_pld_18
    s_cmp_lt_u32 s75, 200000
    s_cbranch_scc1 L_pl_17
    L_pld_18:
L_kvok:
    s_add_u32 s69, s79, 0
    buffer_load_dwordx4 v[80:83], v5, s[48:51], s69 offen sc1
    buffer_load_dwordx4 v[84:87], v6, s[48:51], s69 offen offset:0 sc1
    buffer_load_dwordx4 v[88:91], v6, s[48:51], s69 offen offset:544 sc1
    s_add_u32 s69, s79, 4096
    buffer_load_dwordx4 v[92:95], v5, s[48:51], s69 offen sc1
    buffer_load_dwordx4 v[96:99], v6, s[48:51], s69 offen offset:0 sc1
    buffer_load_dwordx4 v[100:103], v6, s[48:51], s69 offen offset:544 sc1
    s_add_u32 s69, s79, 8192
    buffer_load_dwordx4 v[104:107], v5, s[48:51], s69 offen sc1
    buffer_load_dwordx4 v[108:111], v6, s[48:51], s69 offen offset:0 sc1
    buffer_load_dwordx4 v[112:115], v6, s[48:51], s69 offen offset:544 sc1
    s_add_u32 s69, s79, 12288
    buffer_load_dwordx4 v[116:119], v5, s[48:51], s69 offen sc1
    buffer_load_dwordx4 v[120:123], v6, s[48:51], s69 offen offset:0 sc1
    buffer_load_dwordx4 v[124:127], v6, s[48:51], s69 offen offset:544 sc1
    ds_max_f32 v0, v13 offset:20
    s_mov_b64 exec, 1
    ds_inc_u32 v0, v7 offset:12
    s_mov_b64 exec, -1
L_kvgo:
    s_waitcnt vmcnt(11) lgkmcnt(7)
    v_mfma_f32_32x32x16_bf16 v[16:31], v[80:83], v[48:51], 0
    v_add_u32 v10, 12288, v5
    s_waitcnt vmcnt(9) lgkmcnt(0)
    v_add_u32 v12, 4096, v6
    v_lshlrev_b32 v13, 2, v1
    v_add_u32 v13, s74, v13
    s_nop 6
    v_exp_f32 v16, v16
    v_exp_f32 v17, v17
    v_exp_f32 v18, v18
    v_exp_f32 v19, v19
    v_exp_f32 v20, v20
    v_mfma_f32_32x32x16_bf16 v[32:47], v[80:83], v[52:55], 0
    v_exp_f32 v21, v21
    v_exp_f32 v22, v22
    v_exp_f32 v23, v23
    v_exp_f32 v24, v24
    v_exp_f32 v25, v25
    v_smfmac_f32_32x32x32_bf16 a[0:15], v[84:87], v[16:23], v7
    v_exp_f32 v26, v26
    v_exp_f32 v27, v27
    v_exp_f32 v28, v28
    v_exp_f32 v29, v29
    v_exp_f32 v30, v30
    v_exp_f32 v31, v31
    s_branch L_attn1
.p2align 6
L_attn:
    v_exp_f32 v16, v16
    v_exp_f32 v17, v17
    v_smfmac_f32_32x32x32_bf16 a[112:127], v[112:115], v[40:47], v7
    v_exp_f32 v18, v18
    v_exp_f32 v19, v19
    v_exp_f32 v20, v20
    v_mfma_f32_32x32x16_bf16 v[32:47], v[116:119], v[52:55], 0
    v_exp_f32 v21, v21
    v_exp_f32 v22, v22
    v_exp_f32 v23, v23
    v_exp_f32 v24, v24
    v_exp_f32 v25, v25
    v_smfmac_f32_32x32x32_bf16 a[0:15], v[120:123], v[16:23], v7
    v_exp_f32 v26, v26
    v_exp_f32 v27, v27
    v_exp_f32 v28, v28
    buffer_load_dwordx4 v[104:107], v9, s[48:51], s79 offen sc1
    v_exp_f32 v29, v29
    buffer_load_dwordx4 v[108:111], v14, s[48:51], s79 offen offset:0 sc1
    v_exp_f32 v30, v30
    buffer_load_dwordx4 v[112:115], v14, s[48:51], s79 offen offset:544 sc1
    v_exp_f32 v31, v31
    v_exp_f32 v32, v32
    v_exp_f32 v33, v33
    v_smfmac_f32_32x32x32_bf16 a[0:15], v[124:127], v[24:31], v7
    v_exp_f32 v34, v34
    v_exp_f32 v35, v35
    v_exp_f32 v36, v36
    v_mfma_f32_32x32x16_bf16 v[16:31], v[116:119], v[56:59], 0
    v_exp_f32 v37, v37
    v_exp_f32 v38, v38
    v_exp_f32 v39, v39
    v_exp_f32 v40, v40
    v_exp_f32 v41, v41
    v_smfmac_f32_32x32x32_bf16 a[16:31], v[120:123], v[32:39], v7
    v_exp_f32 v42, v42
    v_exp_f32 v43, v43
    v_exp_f32 v44, v44
    v_exp_f32 v45, v45
    v_exp_f32 v46, v46
    v_exp_f32 v47, v47
    v_exp_f32 v16, v16
    v_exp_f32 v17, v17
    v_smfmac_f32_32x32x32_bf16 a[16:31], v[124:127], v[40:47], v7
    v_exp_f32 v18, v18
    v_exp_f32 v19, v19
    v_exp_f32 v20, v20
    v_mfma_f32_32x32x16_bf16 v[32:47], v[116:119], v[60:63], 0
    v_exp_f32 v21, v21
    v_exp_f32 v22, v22
    v_exp_f32 v23, v23
    v_exp_f32 v24, v24
    v_exp_f32 v25, v25
    v_smfmac_f32_32x32x32_bf16 a[32:47], v[120:123], v[16:23], v7
    v_exp_f32 v26, v26
    v_exp_f32 v27, v27
    v_exp_f32 v28, v28
    v_exp_f32 v29, v29
    v_exp_f32 v30, v30
    v_exp_f32 v31, v31
    v_exp_f32 v32, v32
    v_exp_f32 v33, v33
    v_smfmac_f32_32x32x32_bf16 a[32:47], v[124:127], v[24:31], v7
    v_exp_f32 v34, v34
    v_exp_f32 v35, v35
    v_exp_f32 v36, v36
    v_mfma_f32_32x32x16_bf16 v[16:31], v[116:119], v[64:67], 0
    v_exp_f32 v37, v37
    v_exp_f32 v38, v38
    v_exp_f32 v39, v39
    v_exp_f32 v40, v40
    v_exp_f32 v41, v41
    v_smfmac_f32_32x32x32_bf16 a[48:63], v[120:123], v[32:39], v7
    v_exp_f32 v42, v42
    v_exp_f32 v43, v43
    v_exp_f32 v44, v44
    v_exp_f32 v45, v45
    v_exp_f32 v46, v46
    v_exp_f32 v47, v47
    v_exp_f32 v16, v16
    v_exp_f32 v17, v17
    v_smfmac_f32_32x32x32_bf16 a[48:63], v[124:127], v[40:47], v7
    v_exp_f32 v18, v18
    v_exp_f32 v19, v19
    v_exp_f32 v20, v20
    v_mfma_f32_32x32x16_bf16 v[32:47], v[116:119], v[68:71], 0
    v_exp_f32 v21, v21
    v_exp_f32 v22, v22
    v_exp_f32 v23, v23
    v_exp_f32 v24, v24
    v_exp_f32 v25, v25
    v_smfmac_f32_32x32x32_bf16 a[64:79], v[120:123], v[16:23], v7
    v_exp_f32 v26, v26
    v_exp_f32 v27, v27
    v_exp_f32 v28, v28
    v_exp_f32 v29, v29
    v_exp_f32 v30, v30
    v_exp_f32 v31, v31
    v_exp_f32 v32, v32
    v_exp_f32 v33, v33
    v_smfmac_f32_32x32x32_bf16 a[64:79], v[124:127], v[24:31], v7
    v_exp_f32 v34, v34
    v_exp_f32 v35, v35
    v_exp_f32 v36, v36
    v_mfma_f32_32x32x16_bf16 v[16:31], v[116:119], v[72:75], 0
    v_exp_f32 v37, v37
    v_exp_f32 v38, v38
    v_exp_f32 v39, v39
    v_exp_f32 v40, v40
    v_exp_f32 v41, v41
    v_smfmac_f32_32x32x32_bf16 a[80:95], v[120:123], v[32:39], v7
    v_exp_f32 v42, v42
    v_exp_f32 v43, v43
    v_exp_f32 v44, v44
    v_exp_f32 v45, v45
    v_exp_f32 v46, v46
    v_exp_f32 v47, v47
    v_exp_f32 v16, v16
    v_exp_f32 v17, v17
    v_smfmac_f32_32x32x32_bf16 a[80:95], v[124:127], v[40:47], v7
    v_exp_f32 v18, v18
    v_exp_f32 v19, v19
    v_exp_f32 v20, v20
    v_mfma_f32_32x32x16_bf16 v[32:47], v[116:119], v[76:79], 0
    v_exp_f32 v21, v21
    v_exp_f32 v22, v22
    v_exp_f32 v23, v23
    v_exp_f32 v24, v24
    v_exp_f32 v25, v25
    v_smfmac_f32_32x32x32_bf16 a[96:111], v[120:123], v[16:23], v7
    v_exp_f32 v26, v26
    v_exp_f32 v27, v27
    v_exp_f32 v28, v28
    v_exp_f32 v29, v29
    v_exp_f32 v30, v30
    v_exp_f32 v31, v31
    v_exp_f32 v32, v32
    v_exp_f32 v33, v33
    v_smfmac_f32_32x32x32_bf16 a[96:111], v[124:127], v[24:31], v7
    v_exp_f32 v34, v34
    v_exp_f32 v35, v35
    s_waitcnt vmcnt(6)
    v_exp_f32 v36, v36
    v_mfma_f32_32x32x16_bf16 v[16:31], v[80:83], v[48:51], 0
    v_exp_f32 v37, v37
    v_exp_f32 v38, v38
    v_exp_f32 v39, v39
    v_exp_f32 v40, v40
    v_exp_f32 v41, v41
    v_smfmac_f32_32x32x32_bf16 a[112:127], v[120:123], v[32:39], v7
    v_exp_f32 v42, v42
    v_exp_f32 v43, v43
    v_exp_f32 v44, v44
    v_exp_f32 v45, v45
    v_exp_f32 v46, v46
    v_exp_f32 v47, v47
    v_exp_f32 v16, v16
    v_exp_f32 v17, v17
    v_smfmac_f32_32x32x32_bf16 a[112:127], v[124:127], v[40:47], v7
    v_exp_f32 v18, v18
    v_exp_f32 v19, v19
    v_exp_f32 v20, v20
    v_mfma_f32_32x32x16_bf16 v[32:47], v[80:83], v[52:55], 0
    v_exp_f32 v21, v21
    v_exp_f32 v22, v22
    v_exp_f32 v23, v23
    v_exp_f32 v24, v24
    v_exp_f32 v25, v25
    v_smfmac_f32_32x32x32_bf16 a[0:15], v[84:87], v[16:23], v7
    v_exp_f32 v26, v26
    v_exp_f32 v27, v27
    v_exp_f32 v28, v28
    buffer_load_dwordx4 v[116:119], v10, s[48:51], s79 offen sc1
    v_exp_f32 v29, v29
    buffer_load_dwordx4 v[120:123], v15, s[48:51], s79 offen offset:0 sc1
    v_exp_f32 v30, v30
    buffer_load_dwordx4 v[124:127], v15, s[48:51], s79 offen offset:544 sc1
    v_exp_f32 v31, v31
L_attn1:
    v_exp_f32 v32, v32
    v_exp_f32 v33, v33
    v_smfmac_f32_32x32x32_bf16 a[0:15], v[88:91], v[24:31], v7
    v_exp_f32 v34, v34
    v_exp_f32 v35, v35
    v_exp_f32 v36, v36
    v_mfma_f32_32x32x16_bf16 v[16:31], v[80:83], v[56:59], 0
    v_exp_f32 v37, v37
    v_exp_f32 v38, v38
    v_exp_f32 v39, v39
    v_exp_f32 v40, v40
    v_exp_f32 v41, v41
    v_smfmac_f32_32x32x32_bf16 a[16:31], v[84:87], v[32:39], v7
    v_exp_f32 v42, v42
    v_exp_f32 v43, v43
    v_exp_f32 v44, v44
    v_exp_f32 v45, v45
    s_add_u32 s79, s79, 16384
    v_exp_f32 v46, v46
    s_and_b32 s79, s79, 0xffff
    v_exp_f32 v47, v47
    v_exp_f32 v16, v16
    v_exp_f32 v17, v17
    v_smfmac_f32_32x32x32_bf16 a[16:31], v[88:91], v[40:47], v7
    v_exp_f32 v18, v18
    v_exp_f32 v19, v19
    v_exp_f32 v20, v20
    v_mfma_f32_32x32x16_bf16 v[32:47], v[80:83], v[60:63], 0
    v_exp_f32 v21, v21
    v_exp_f32 v22, v22
    v_exp_f32 v23, v23
    v_exp_f32 v24, v24
    v_exp_f32 v25, v25
    v_smfmac_f32_32x32x32_bf16 a[32:47], v[84:87], v[16:23], v7
    v_exp_f32 v26, v26
    v_exp_f32 v27, v27
    v_exp_f32 v28, v28
    v_exp_f32 v29, v29
    v_exp_f32 v30, v30
    v_exp_f32 v31, v31
    v_exp_f32 v32, v32
    v_exp_f32 v33, v33
    v_smfmac_f32_32x32x32_bf16 a[32:47], v[88:91], v[24:31], v7
    v_exp_f32 v34, v34
    v_exp_f32 v35, v35
    v_exp_f32 v36, v36
    v_mfma_f32_32x32x16_bf16 v[16:31], v[80:83], v[64:67], 0
    v_exp_f32 v37, v37
    v_exp_f32 v38, v38
    v_exp_f32 v39, v39
    v_exp_f32 v40, v40
    v_exp_f32 v41, v41
    v_smfmac_f32_32x32x32_bf16 a[48:63], v[84:87], v[32:39], v7
    v_exp_f32 v42, v42
    v_exp_f32 v43, v43
    v_exp_f32 v44, v44
    v_exp_f32 v45, v45
    v_exp_f32 v46, v46
    v_exp_f32 v47, v47
    v_exp_f32 v16, v16
    v_exp_f32 v17, v17
    v_smfmac_f32_32x32x32_bf16 a[48:63], v[88:91], v[40:47], v7
    v_exp_f32 v18, v18
    v_exp_f32 v19, v19
    v_exp_f32 v20, v20
    v_mfma_f32_32x32x16_bf16 v[32:47], v[80:83], v[68:71], 0
    v_exp_f32 v21, v21
    v_exp_f32 v22, v22
    v_exp_f32 v23, v23
    v_exp_f32 v24, v24
    v_exp_f32 v25, v25
    v_smfmac_f32_32x32x32_bf16 a[64:79], v[84:87], v[16:23], v7
    v_exp_f32 v26, v26
    v_exp_f32 v27, v27
    v_exp_f32 v28, v28
    v_exp_f32 v29, v29
    v_exp_f32 v30, v30
    v_exp_f32 v31, v31
    v_exp_f32 v32, v32
    v_exp_f32 v33, v33
    v_smfmac_f32_32x32x32_bf16 a[64:79], v[88:91], v[24:31], v7
    v_exp_f32 v34, v34
    v_exp_f32 v35, v35
    v_exp_f32 v36, v36
    v_mfma_f32_32x32x16_bf16 v[16:31], v[80:83], v[72:75], 0
    v_exp_f32 v37, v37
    v_exp_f32 v38, v38
    v_exp_f32 v39, v39
    v_exp_f32 v40, v40
    v_exp_f32 v41, v41
    v_smfmac_f32_32x32x32_bf16 a[80:95], v[84:87], v[32:39], v7
    v_exp_f32 v42, v42
    v_exp_f32 v43, v43
    v_exp_f32 v44, v44
    v_exp_f32 v45, v45
    v_exp_f32 v46, v46
    v_exp_f32 v47, v47
    v_exp_f32 v16, v16
    v_exp_f32 v17, v17
    v_smfmac_f32_32x32x32_bf16 a[80:95], v[88:91], v[40:47], v7
    v_exp_f32 v18, v18
    v_exp_f32 v19, v19
    v_exp_f32 v20, v20
    v_mfma_f32_32x32x16_bf16 v[32:47], v[80:83], v[76:79], 0
    v_exp_f32 v21, v21
    v_exp_f32 v22, v22
    v_exp_f32 v23, v23
    v_exp_f32 v24, v24
    v_exp_f32 v25, v25
    v_smfmac_f32_32x32x32_bf16 a[96:111], v[84:87], v[16:23], v7
    v_exp_f32 v26, v26
    v_exp_f32 v27, v27
    v_exp_f32 v28, v28
    v_exp_f32 v29, v29
    v_exp_f32 v30, v30
    v_exp_f32 v31, v31
    v_exp_f32 v32, v32
    v_exp_f32 v33, v33
    v_smfmac_f32_32x32x32_bf16 a[96:111], v[88:91], v[24:31], v7
    v_exp_f32 v34, v34
    v_exp_f32 v35, v35
    s_waitcnt vmcnt(6)
    v_exp_f32 v36, v36
    v_mfma_f32_32x32x16_bf16 v[16:31], v[92:95], v[48:51], 0
    v_exp_f32 v37, v37
    v_exp_f32 v38, v38
    v_exp_f32 v39, v39
    v_exp_f32 v40, v40
    v_exp_f32 v41, v41
    v_smfmac_f32_32x32x32_bf16 a[112:127], v[84:87], v[32:39], v7
    v_exp_f32 v42, v42
    v_exp_f32 v43, v43
    v_exp_f32 v44, v44
    v_exp_f32 v45, v45
    v_exp_f32 v46, v46
    v_exp_f32 v47, v47
    v_exp_f32 v16, v16
    v_exp_f32 v17, v17
    v_smfmac_f32_32x32x32_bf16 a[112:127], v[88:91], v[40:47], v7
    v_exp_f32 v18, v18
    v_exp_f32 v19, v19
    v_exp_f32 v20, v20
    v_mfma_f32_32x32x16_bf16 v[32:47], v[92:95], v[52:55], 0
    v_exp_f32 v21, v21
    v_exp_f32 v22, v22
    v_exp_f32 v23, v23
    v_exp_f32 v24, v24
    v_exp_f32 v25, v25
    v_smfmac_f32_32x32x32_bf16 a[0:15], v[96:99], v[16:23], v7
    v_exp_f32 v26, v26
    v_exp_f32 v27, v27
    v_exp_f32 v28, v28
    buffer_load_dwordx4 v[80:83], v5, s[48:51], s79 offen sc1
    v_exp_f32 v29, v29
    buffer_load_dwordx4 v[84:87], v6, s[48:51], s79 offen offset:0 sc1
    v_exp_f32 v30, v30
    buffer_load_dwordx4 v[88:91], v6, s[48:51], s79 offen offset:544 sc1
    v_exp_f32 v31, v31
    v_exp_f32 v32, v32
    v_exp_f32 v33, v33
    v_smfmac_f32_32x32x32_bf16 a[0:15], v[100:103], v[24:31], v7
    v_exp_f32 v34, v34
    v_exp_f32 v35, v35
    v_exp_f32 v36, v36
    v_mfma_f32_32x32x16_bf16 v[16:31], v[92:95], v[56:59], 0
    v_exp_f32 v37, v37
    v_exp_f32 v38, v38
    v_exp_f32 v39, v39
    v_exp_f32 v40, v40
    v_exp_f32 v41, v41
    v_smfmac_f32_32x32x32_bf16 a[16:31], v[96:99], v[32:39], v7
    v_exp_f32 v42, v42
    v_exp_f32 v43, v43
    v_exp_f32 v44, v44
    v_exp_f32 v45, v45
    v_exp_f32 v46, v46
    v_exp_f32 v47, v47
    v_exp_f32 v16, v16
    v_exp_f32 v17, v17
    v_smfmac_f32_32x32x32_bf16 a[16:31], v[100:103], v[40:47], v7
    v_exp_f32 v18, v18
    v_exp_f32 v19, v19
    v_exp_f32 v20, v20
    v_mfma_f32_32x32x16_bf16 v[32:47], v[92:95], v[60:63], 0
    v_exp_f32 v21, v21
    v_exp_f32 v22, v22
    v_exp_f32 v23, v23
    v_exp_f32 v24, v24
    v_exp_f32 v25, v25
    v_smfmac_f32_32x32x32_bf16 a[32:47], v[96:99], v[16:23], v7
    v_exp_f32 v26, v26
    v_exp_f32 v27, v27
    v_exp_f32 v28, v28
    v_exp_f32 v29, v29
    v_exp_f32 v30, v30
    v_exp_f32 v31, v31
    v_exp_f32 v32, v32
    v_exp_f32 v33, v33
    v_smfmac_f32_32x32x32_bf16 a[32:47], v[100:103], v[24:31], v7
    v_exp_f32 v34, v34
    v_exp_f32 v35, v35
    v_exp_f32 v36, v36
    v_mfma_f32_32x32x16_bf16 v[16:31], v[92:95], v[64:67], 0
    v_exp_f32 v37, v37
    v_exp_f32 v38, v38
    v_exp_f32 v39, v39
    v_exp_f32 v40, v40
    v_exp_f32 v41, v41
    v_smfmac_f32_32x32x32_bf16 a[48:63], v[96:99], v[32:39], v7
    v_exp_f32 v42, v42
    v_exp_f32 v43, v43
    v_exp_f32 v44, v44
    v_exp_f32 v45, v45
    v_exp_f32 v46, v46
    v_exp_f32 v47, v47
    v_exp_f32 v16, v16
    v_exp_f32 v17, v17
    v_smfmac_f32_32x32x32_bf16 a[48:63], v[100:103], v[40:47], v7
    v_exp_f32 v18, v18
    v_exp_f32 v19, v19
    v_exp_f32 v20, v20
    v_mfma_f32_32x32x16_bf16 v[32:47], v[92:95], v[68:71], 0
    v_exp_f32 v21, v21
    v_exp_f32 v22, v22
    v_exp_f32 v23, v23
    v_exp_f32 v24, v24
    v_exp_f32 v25, v25
    v_smfmac_f32_32x32x32_bf16 a[64:79], v[96:99], v[16:23], v7
    v_exp_f32 v26, v26
    v_exp_f32 v27, v27
    v_exp_f32 v28, v28
    v_exp_f32 v29, v29
    v_exp_f32 v30, v30
    v_exp_f32 v31, v31
    v_exp_f32 v32, v32
    v_exp_f32 v33, v33
    v_smfmac_f32_32x32x32_bf16 a[64:79], v[100:103], v[24:31], v7
    v_exp_f32 v34, v34
    v_exp_f32 v35, v35
    v_exp_f32 v36, v36
    v_mfma_f32_32x32x16_bf16 v[16:31], v[92:95], v[72:75], 0
    v_exp_f32 v37, v37
    v_exp_f32 v38, v38
    v_exp_f32 v39, v39
    v_exp_f32 v40, v40
    v_exp_f32 v41, v41
    v_smfmac_f32_32x32x32_bf16 a[80:95], v[96:99], v[32:39], v7
    v_exp_f32 v42, v42
    v_exp_f32 v43, v43
    v_exp_f32 v44, v44
    v_exp_f32 v45, v45
    v_exp_f32 v46, v46
    v_exp_f32 v47, v47
    v_exp_f32 v16, v16
    v_exp_f32 v17, v17
    v_smfmac_f32_32x32x32_bf16 a[80:95], v[100:103], v[40:47], v7
    v_exp_f32 v18, v18
    v_exp_f32 v19, v19
    v_exp_f32 v20, v20
    v_mfma_f32_32x32x16_bf16 v[32:47], v[92:95], v[76:79], 0
    v_exp_f32 v21, v21
    v_exp_f32 v22, v22
    v_exp_f32 v23, v23
    v_exp_f32 v24, v24
    v_exp_f32 v25, v25
    v_smfmac_f32_32x32x32_bf16 a[96:111], v[96:99], v[16:23], v7
    v_exp_f32 v26, v26
    v_exp_f32 v27, v27
    v_exp_f32 v28, v28
    v_exp_f32 v29, v29
    v_exp_f32 v30, v30
    v_exp_f32 v31, v31
    v_exp_f32 v32, v32
    v_exp_f32 v33, v33
    v_smfmac_f32_32x32x32_bf16 a[96:111], v[100:103], v[24:31], v7
    v_exp_f32 v34, v34
    v_exp_f32 v35, v35
    s_waitcnt vmcnt(6)
    v_exp_f32 v36, v36
    v_mfma_f32_32x32x16_bf16 v[16:31], v[104:107], v[48:51], 0
    v_exp_f32 v37, v37
    v_exp_f32 v38, v38
    v_exp_f32 v39, v39
    v_exp_f32 v40, v40
    v_exp_f32 v41, v41
    v_smfmac_f32_32x32x32_bf16 a[112:127], v[96:99], v[32:39], v7
    v_exp_f32 v42, v42
    v_exp_f32 v43, v43
    v_exp_f32 v44, v44
    v_exp_f32 v45, v45
    v_exp_f32 v46, v46
    v_exp_f32 v47, v47
    v_exp_f32 v16, v16
    v_exp_f32 v17, v17
    v_smfmac_f32_32x32x32_bf16 a[112:127], v[100:103], v[40:47], v7
    v_exp_f32 v18, v18
    v_exp_f32 v19, v19
    v_exp_f32 v20, v20
    v_mfma_f32_32x32x16_bf16 v[32:47], v[104:107], v[52:55], 0
    v_exp_f32 v21, v21
    v_exp_f32 v22, v22
    v_exp_f32 v23, v23
    v_exp_f32 v24, v24
    v_exp_f32 v25, v25
    v_smfmac_f32_32x32x32_bf16 a[0:15], v[108:111], v[16:23], v7
    v_exp_f32 v26, v26
    v_exp_f32 v27, v27
    v_exp_f32 v28, v28
    buffer_load_dwordx4 v[92:95], v8, s[48:51], s79 offen sc1
    v_exp_f32 v29, v29
    buffer_load_dwordx4 v[96:99], v12, s[48:51], s79 offen offset:0 sc1
    v_exp_f32 v30, v30
    buffer_load_dwordx4 v[100:103], v12, s[48:51], s79 offen offset:544 sc1
    v_exp_f32 v31, v31
    v_exp_f32 v32, v32
    v_exp_f32 v33, v33
    v_smfmac_f32_32x32x32_bf16 a[0:15], v[112:115], v[24:31], v7
    v_exp_f32 v34, v34
    v_exp_f32 v35, v35
    v_exp_f32 v36, v36
    v_mfma_f32_32x32x16_bf16 v[16:31], v[104:107], v[56:59], 0
    v_exp_f32 v37, v37
    v_exp_f32 v38, v38
    v_exp_f32 v39, v39
    v_exp_f32 v40, v40
    v_exp_f32 v41, v41
    v_smfmac_f32_32x32x32_bf16 a[16:31], v[108:111], v[32:39], v7
    v_exp_f32 v42, v42
    v_exp_f32 v43, v43
    v_exp_f32 v44, v44
    v_exp_f32 v45, v45
    v_exp_f32 v46, v46
    v_exp_f32 v47, v47
    v_exp_f32 v16, v16
    v_exp_f32 v17, v17
    v_smfmac_f32_32x32x32_bf16 a[16:31], v[112:115], v[40:47], v7
    v_exp_f32 v18, v18
    v_exp_f32 v19, v19
    v_exp_f32 v20, v20
    v_mfma_f32_32x32x16_bf16 v[32:47], v[104:107], v[60:63], 0
    v_exp_f32 v21, v21
    v_exp_f32 v22, v22
    v_exp_f32 v23, v23
    v_exp_f32 v24, v24
    v_exp_f32 v25, v25
    v_smfmac_f32_32x32x32_bf16 a[32:47], v[108:111], v[16:23], v7
    v_exp_f32 v26, v26
    v_exp_f32 v27, v27
    v_exp_f32 v28, v28
    v_exp_f32 v29, v29
    v_exp_f32 v30, v30
    v_exp_f32 v31, v31
    v_exp_f32 v32, v32
    v_exp_f32 v33, v33
    v_smfmac_f32_32x32x32_bf16 a[32:47], v[112:115], v[24:31], v7
    v_exp_f32 v34, v34
    v_exp_f32 v35, v35
    v_exp_f32 v36, v36
    v_mfma_f32_32x32x16_bf16 v[16:31], v[104:107], v[64:67], 0
    v_exp_f32 v37, v37
    v_exp_f32 v38, v38
    v_exp_f32 v39, v39
    v_exp_f32 v40, v40
    v_exp_f32 v41, v41
    v_smfmac_f32_32x32x32_bf16 a[48:63], v[108:111], v[32:39], v7
    v_exp_f32 v42, v42
    v_exp_f32 v43, v43
    v_exp_f32 v44, v44
    v_exp_f32 v45, v45
    v_exp_f32 v46, v46
    v_exp_f32 v47, v47
    v_exp_f32 v16, v16
    v_exp_f32 v17, v17
    v_smfmac_f32_32x32x32_bf16 a[48:63], v[112:115], v[40:47], v7
    v_exp_f32 v18, v18
    v_exp_f32 v19, v19
    v_exp_f32 v20, v20
    v_mfma_f32_32x32x16_bf16 v[32:47], v[104:107], v[68:71], 0
    v_exp_f32 v21, v21
    v_exp_f32 v22, v22
    v_exp_f32 v23, v23
    v_exp_f32 v24, v24
    v_exp_f32 v25, v25
    v_smfmac_f32_32x32x32_bf16 a[64:79], v[108:111], v[16:23], v7
    v_exp_f32 v26, v26
    v_exp_f32 v27, v27
    v_exp_f32 v28, v28
    v_exp_f32 v29, v29
    v_exp_f32 v30, v30
    v_exp_f32 v31, v31
    v_exp_f32 v32, v32
    v_exp_f32 v33, v33
    v_smfmac_f32_32x32x32_bf16 a[64:79], v[112:115], v[24:31], v7
    v_exp_f32 v34, v34
    v_exp_f32 v35, v35
    v_exp_f32 v36, v36
    v_mfma_f32_32x32x16_bf16 v[16:31], v[104:107], v[72:75], 0
    v_exp_f32 v37, v37
    v_exp_f32 v38, v38
    v_exp_f32 v39, v39
    v_exp_f32 v40, v40
    v_exp_f32 v41, v41
    v_smfmac_f32_32x32x32_bf16 a[80:95], v[108:111], v[32:39], v7
    v_exp_f32 v42, v42
    v_exp_f32 v43, v43
    v_exp_f32 v44, v44
    v_exp_f32 v45, v45
    v_exp_f32 v46, v46
    v_exp_f32 v47, v47
    v_exp_f32 v16, v16
    v_exp_f32 v17, v17
    v_smfmac_f32_32x32x32_bf16 a[80:95], v[112:115], v[40:47], v7
    v_exp_f32 v18, v18
    v_exp_f32 v19, v19
    v_exp_f32 v20, v20
    v_mfma_f32_32x32x16_bf16 v[32:47], v[104:107], v[76:79], 0
    v_exp_f32 v21, v21
    v_exp_f32 v22, v22
    v_exp_f32 v23, v23
    v_exp_f32 v24, v24
    v_exp_f32 v25, v25
    v_smfmac_f32_32x32x32_bf16 a[96:111], v[108:111], v[16:23], v7
    v_exp_f32 v26, v26
    v_exp_f32 v27, v27
    v_exp_f32 v28, v28
    v_exp_f32 v29, v29
    v_exp_f32 v30, v30
    v_exp_f32 v31, v31
    v_exp_f32 v32, v32
    v_exp_f32 v33, v33
    v_smfmac_f32_32x32x32_bf16 a[96:111], v[112:115], v[24:31], v7
    v_exp_f32 v34, v34
    v_exp_f32 v35, v35
    s_waitcnt vmcnt(6)
    v_exp_f32 v36, v36
    v_mfma_f32_32x32x16_bf16 v[16:31], v[116:119], v[48:51], 0
    v_exp_f32 v37, v37
    v_exp_f32 v38, v38
    v_exp_f32 v39, v39
    v_exp_f32 v40, v40
    v_exp_f32 v41, v41
    v_smfmac_f32_32x32x32_bf16 a[112:127], v[108:111], v[32:39], v7
    v_exp_f32 v42, v42
    v_exp_f32 v43, v43
    v_exp_f32 v44, v44
    v_exp_f32 v45, v45
    s_sub_u32 s78, s78, 1
    v_exp_f32 v46, v46
    s_cmp_eq_u32 s78, 0
    v_exp_f32 v47, v47
    s_cbranch_scc0 L_attn
    v_exp_f32 v16, v16
    v_exp_f32 v17, v17
    v_smfmac_f32_32x32x32_bf16 a[112:127], v[112:115], v[40:47], v7
    v_exp_f32 v18, v18
    ds_read_b32 v12, v0 offset:28
    v_exp_f32 v19, v19
    v_exp_f32 v20, v20
    v_mfma_f32_32x32x16_bf16 v[32:47], v[116:119], v[52:55], 0
    v_exp_f32 v21, v21
    v_exp_f32 v22, v22
    v_exp_f32 v23, v23
    v_exp_f32 v24, v24
    v_exp_f32 v25, v25
    v_smfmac_f32_32x32x32_bf16 a[0:15], v[120:123], v[16:23], v7
    v_exp_f32 v26, v26
    v_exp_f32 v27, v27
    v_exp_f32 v28, v28
    v_exp_f32 v29, v29
    v_exp_f32 v30, v30
    v_exp_f32 v31, v31
    s_waitcnt lgkmcnt(0)
    v_readfirstlane_b32 s68, v12
    s_cmp_ge_u32 s68, 6
    s_cbranch_scc1 L_sfree0
    s_mov_b32 s75, 0
    L_sy_19:
    ds_read_b32 v12, v0 offset:28
    s_add_u32 s75, s75, 1
    s_waitcnt lgkmcnt(0)
    v_readfirstlane_b32 s68, v12
    s_cmp_ge_u32 s68, 6
    s_cbranch_scc1 L_syd_20
    s_sleep 2
    s_cmp_lt_u32 s75, 200000
    s_cbranch_scc1 L_sy_19
    L_syd_20:
L_sfree0:
    v_exp_f32 v32, v32
    v_exp_f32 v33, v33
    v_smfmac_f32_32x32x32_bf16 a[0:15], v[124:127], v[24:31], v7
    v_exp_f32 v34, v34
    v_exp_f32 v35, v35
    v_exp_f32 v36, v36
    v_mfma_f32_32x32x16_bf16 v[16:31], v[116:119], v[56:59], 0
    v_exp_f32 v37, v37
    v_exp_f32 v38, v38
    v_exp_f32 v39, v39
    v_exp_f32 v40, v40
    v_exp_f32 v41, v41
    v_smfmac_f32_32x32x32_bf16 a[16:31], v[120:123], v[32:39], v7
    v_exp_f32 v42, v42
    v_exp_f32 v43, v43
    v_exp_f32 v44, v44
    ds_write_b128 v11, a[0:3] offset:27648
    v_exp_f32 v45, v45
    ds_write_b128 v11, a[4:7] offset:28672
    v_exp_f32 v46, v46
    ds_write_b32 v13, a8 offset:29696
    v_exp_f32 v47, v47
    s_mov_b64 exec, 1
    ds_inc_u32 v0, v7 offset:12
    s_mov_b64 exec, -1
    v_exp_f32 v16, v16
    v_exp_f32 v17, v17
    v_smfmac_f32_32x32x32_bf16 a[16:31], v[124:127], v[40:47], v7
    v_exp_f32 v18, v18
    v_exp_f32 v19, v19
    v_exp_f32 v20, v20
    v_mfma_f32_32x32x16_bf16 v[32:47], v[116:119], v[60:63], 0
    v_exp_f32 v21, v21
    v_exp_f32 v22, v22
    v_exp_f32 v23, v23
    v_exp_f32 v24, v24
    v_exp_f32 v25, v25
    v_smfmac_f32_32x32x32_bf16 a[32:47], v[120:123], v[16:23], v7
    v_exp_f32 v26, v26
    v_exp_f32 v27, v27
    v_exp_f32 v28, v28
    ds_write_b128 v11, a[16:19] offset:29952
    v_exp_f32 v29, v29
    ds_write_b128 v11, a[20:23] offset:30976
    v_exp_f32 v30, v30
    ds_write_b32 v13, a24 offset:32000
    v_exp_f32 v31, v31
    v_exp_f32 v32, v32
    v_exp_f32 v33, v33
    v_smfmac_f32_32x32x32_bf16 a[32:47], v[124:127], v[24:31], v7
    v_exp_f32 v34, v34
    ds_read_b32 v12, v0 offset:8
    v_exp_f32 v35, v35
    v_exp_f32 v36, v36
    v_mfma_f32_32x32x16_bf16 v[16:31], v[116:119], v[64:67], 0
    v_exp_f32 v37, v37
    v_exp_f32 v38, v38
    v_exp_f32 v39, v39
    v_exp_f32 v40, v40
    v_exp_f32 v41, v41
    v_smfmac_f32_32x32x32_bf16 a[48:63], v[120:123], v[32:39], v7
    v_exp_f32 v42, v42
    v_exp_f32 v43, v43
    v_exp_f32 v44, v44
    ds_write_b128 v11, a[32:35] offset:32256
    v_exp_f32 v45, v45
    ds_write_b128 v11, a[36:39] offset:33280
    v_exp_f32 v46, v46
    ds_write_b32 v13, a40 offset:34304
    v_exp_f32 v47, v47
    s_waitcnt lgkmcnt(0)
    v_readfirstlane_b32 s68, v12
    s_cmp_ge_u32 s68, 4
    s_cbranch_scc1 L_sfree3
    s_mov_b32 s75, 0
    L_sy_21:
    ds_read_b32 v12, v0 offset:8
    s_add_u32 s75, s75, 1
    s_waitcnt lgkmcnt(0)
    v_readfirstlane_b32 s68, v12
    s_cmp_ge_u32 s68, 4
    s_cbranch_scc1 L_syd_22
    s_sleep 2
    s_cmp_lt_u32 s75, 200000
    s_cbranch_scc1 L_sy_21
    L_syd_22:
L_sfree3:
    v_exp_f32 v16, v16
    v_exp_f32 v17, v17
    v_smfmac_f32_32x32x32_bf16 a[48:63], v[124:127], v[40:47], v7
    v_exp_f32 v18, v18
    v_exp_f32 v19, v19
    v_exp_f32 v20, v20
    v_mfma_f32_32x32x16_bf16 v[32:47], v[116:119], v[68:71], 0
    v_exp_f32 v21, v21
    v_exp_f32 v22, v22
    v_exp_f32 v23, v23
    v_exp_f32 v24, v24
    v_exp_f32 v25, v25
    v_smfmac_f32_32x32x32_bf16 a[64:79], v[120:123], v[16:23], v7
    s_add_u32 s68, s3, 1
    s_and_b32 s68, s68, 3
    s_mul_i32 s68, s68, 6912
    s_add_u32 s68, s68, 105472
    v_add_u32 v8, s68, v4
    v_lshl_add_u32 v12, v2, 2, s68
    s_add_u32 s68, s3, 2
    s_and_b32 s68, s68, 3
    s_mul_i32 s68, s68, 6912
    s_add_u32 s68, s68, 105472
    v_add_u32 v9, s68, v4
    v_lshl_add_u32 v14, v2, 2, s68
    v_exp_f32 v26, v26
    v_exp_f32 v27, v27
    v_exp_f32 v28, v28
    ds_write_b128 v11, a[48:51] offset:0
    v_exp_f32 v29, v29
    ds_write_b128 v11, a[52:55] offset:1024
    v_exp_f32 v30, v30
    ds_write_b32 v13, a56 offset:2048
    v_exp_f32 v31, v31
    v_exp_f32 v32, v32
    v_exp_f32 v33, v33
    v_smfmac_f32_32x32x32_bf16 a[64:79], v[124:127], v[24:31], v7
    v_exp_f32 v34, v34
    v_exp_f32 v35, v35
    v_exp_f32 v36, v36
    v_mfma_f32_32x32x16_bf16 v[16:31], v[116:119], v[72:75], 0
    v_exp_f32 v37, v37
    v_exp_f32 v38, v38
    v_exp_f32 v39, v39
    v_exp_f32 v40, v40
    v_exp_f32 v41, v41
    v_smfmac_f32_32x32x32_bf16 a[80:95], v[120:123], v[32:39], v7
    s_add_u32 s68, s3, 3
    s_and_b32 s68, s68, 3
    s_mul_i32 s68, s68, 6912
    s_add_u32 s68, s68, 105472
    v_add_u32 v10, s68, v4
    v_lshl_add_u32 v15, v2, 2, s68
    s_lshl_b32 s69, s5, 2
    s_add_u32 s69, s69, s3
    s_lshl_b32 s69, s69, 10
    s_lshl_b32 s70, s4, 16
    s_add_u32 s69, s69, s70
    s_add_u32 s69, s69, 1048576
    s_add_u32 s70, s69, 32768
    s_waitcnt vmcnt(0)
    v_exp_f32 v42, v42
    v_exp_f32 v43, v43
    v_exp_f32 v44, v44
    ds_write_b128 v11, a[64:67] offset:2304
    v_exp_f32 v45, v45
    ds_write_b128 v11, a[68:71] offset:3328
    v_exp_f32 v46, v46
    ds_write_b32 v13, a72 offset:4352
    v_exp_f32 v47, v47
    v_exp_f32 v16, v16
    v_exp_f32 v17, v17
    v_smfmac_f32_32x32x32_bf16 a[80:95], v[124:127], v[40:47], v7
    v_exp_f32 v18, v18
    v_exp_f32 v19, v19
    v_exp_f32 v20, v20
    v_mfma_f32_32x32x16_bf16 v[32:47], v[116:119], v[76:79], 0
    v_exp_f32 v21, v21
    v_exp_f32 v22, v22
    v_exp_f32 v23, v23
    v_exp_f32 v24, v24
    v_exp_f32 v25, v25
    v_smfmac_f32_32x32x32_bf16 a[96:111], v[120:123], v[16:23], v7
    v_exp_f32 v26, v26
    v_exp_f32 v27, v27
    v_exp_f32 v28, v28
    ds_write_b128 v11, a[80:83] offset:4608
    v_exp_f32 v29, v29
    ds_write_b128 v11, a[84:87] offset:5632
    v_exp_f32 v30, v30
    ds_write_b32 v13, a88 offset:6656
    v_exp_f32 v31, v31
    v_exp_f32 v32, v32
    v_exp_f32 v33, v33
    v_smfmac_f32_32x32x32_bf16 a[96:111], v[124:127], v[24:31], v7
    v_exp_f32 v34, v34
    s_waitcnt lgkmcnt(0)
    s_mov_b64 exec, 1
    ds_inc_u32 v0, v7 offset:4
    s_mov_b64 exec, -1
    v_exp_f32 v35, v35
    v_exp_f32 v36, v36
    v_exp_f32 v37, v37
    v_exp_f32 v38, v38
    v_exp_f32 v39, v39
    v_exp_f32 v40, v40
    v_exp_f32 v41, v41
    v_smfmac_f32_32x32x32_bf16 a[112:127], v[120:123], v[32:39], v7
    s_mov_b32 s75, 0
    L_sy_23:
    ds_read_b32 v16, v0 offset:4
    s_add_u32 s75, s75, 1
    s_waitcnt lgkmcnt(0)
    v_readfirstlane_b32 s68, v16
    s_cmp_ge_u32 s68, 16
    s_cbranch_scc1 L_syd_24
    s_cmp_lt_u32 s75, 200000
    s_cbranch_scc1 L_sy_23
    L_syd_24:
    ds_read_b64 v[118:119], v0 offset:16
    ds_read_b32 v112, v12 offset:4352
    ds_read_b32 v113, v14 offset:34304
    ds_read_b32 v114, v15 offset:29696
    ds_read_b128 v[16:19], v8 offset:2304
    ds_read_b128 v[20:23], v8 offset:3328
    ds_read_b128 v[24:27], v9 offset:32256
    ds_read_b128 v[28:31], v9 offset:33280
    ds_read_b128 v[80:83], v10 offset:27648
    ds_read_b128 v[84:87], v10 offset:28672
    s_waitcnt lgkmcnt(6)
    v_exp_f32 v42, v42
    v_exp_f32 v43, v43
    ds_read_b32 v115, v12 offset:6656
    ds_read_b32 v116, v14 offset:2048
    ds_read_b32 v117, v15 offset:32000
    ds_read_b128 v[88:91], v8 offset:4608
    ds_read_b128 v[92:95], v8 offset:5632
    ds_read_b128 v[96:99], v9 offset:0
    ds_read_b128 v[100:103], v9 offset:1024
    ds_read_b128 v[104:107], v10 offset:29952
    ds_read_b128 v[108:111], v10 offset:30976
    v_exp_f32 v44, v44
    v_exp_f32 v45, v45
    v_exp_f32 v46, v46
    v_exp_f32 v47, v47
    s_mov_b32 s65, 16
    s_nop 0
    v_smfmac_f32_32x32x32_bf16 a[112:127], v[124:127], v[40:47], v7
L_comb2:
    s_setprio 3
    s_waitcnt lgkmcnt(9)
    v_accvgpr_read_b32 v120, a104
    v_accvgpr_read_b32 v121, a104
    v_mul_f32 v118, v118, v119
    v_add_f32 v112, v112, v113
    v_permlane32_swap_b32 v120, v121
    v_cmp_nge_f32 vcc, 1148846080, v118
    v_add_f32 v120, v120, v114
    v_add_f32 v120, v120, v112
    v_rcp_f32 v120, v120
    s_cbranch_vccnz L_slow
L_fast:
    v_accvgpr_read_b32 v32, a96
    v_accvgpr_read_b32 v33, a97
    v_accvgpr_read_b32 v34, a98
    v_accvgpr_read_b32 v35, a99
    v_accvgpr_read_b32 v36, a100
    v_accvgpr_read_b32 v37, a101
    v_accvgpr_read_b32 v38, a102
    v_accvgpr_read_b32 v39, a103
    v_pk_add_f32 v[16:17], v[16:17], v[24:25]
    v_pk_add_f32 v[18:19], v[18:19], v[26:27]
    v_pk_add_f32 v[20:21], v[20:21], v[28:29]
    v_pk_add_f32 v[22:23], v[22:23], v[30:31]
    v_pk_add_f32 v[32:33], v[32:33], v[80:81]
    v_pk_add_f32 v[34:35], v[34:35], v[82:83]
    v_pk_add_f32 v[36:37], v[36:37], v[84:85]
    v_pk_add_f32 v[38:39], v[38:39], v[86:87]
    v_pk_add_f32 v[32:33], v[32:33], v[16:17]
    v_pk_add_f32 v[34:35], v[34:35], v[18:19]
    v_pk_add_f32 v[36:37], v[36:37], v[20:21]
    v_pk_add_f32 v[38:39], v[38:39], v[22:23]
    v_pk_mul_f32 v[32:33], v[32:33], v[120:121] op_sel_hi:[1,0]
    v_pk_mul_f32 v[34:35], v[34:35], v[120:121] op_sel_hi:[1,0]
    v_pk_mul_f32 v[36:37], v[36:37], v[120:121] op_sel_hi:[1,0]
    v_pk_mul_f32 v[38:39], v[38:39], v[120:121] op_sel_hi:[1,0]
    v_cvt_pk_bf16_f32 v16, v32, v33
    v_cvt_pk_bf16_f32 v17, v34, v35
    v_cvt_pk_bf16_f32 v18, v36, v37
    v_cvt_pk_bf16_f32 v19, v38, v39
    buffer_store_dwordx4 v[16:19], v4, s[48:51], s69 offen sc1
    v_accvgpr_read_b32 v40, a112
    v_accvgpr_read_b32 v41, a113
    v_accvgpr_read_b32 v42, a114
    v_accvgpr_read_b32 v43, a115
    v_accvgpr_read_b32 v44, a116
    v_accvgpr_read_b32 v45, a117
    v_accvgpr_read_b32 v46, a118
    v_accvgpr_read_b32 v47, a119
    v_accvgpr_read_b32 v122, a120
    v_accvgpr_read_b32 v123, a120
    s_waitcnt lgkmcnt(2)
    v_add_f32 v115, v115, v116
    v_permlane32_swap_b32 v122, v123
    v_add_f32 v115, v115, v117
    v_add_f32 v122, v122, v115
    v_rcp_f32 v122, v122
    v_pk_add_f32 v[88:89], v[88:89], v[96:97]
    v_pk_add_f32 v[90:91], v[90:91], v[98:99]
    v_pk_add_f32 v[92:93], v[92:93], v[100:101]
    v_pk_add_f32 v[94:95], v[94:95], v[102:103]
    s_waitcnt lgkmcnt(0)
    s_mov_b64 exec, 1
    ds_inc_u32 v0, v7 offset:12
    s_mov_b64 exec, -1
    v_pk_add_f32 v[40:41], v[40:41], v[104:105]
    v_pk_add_f32 v[42:43], v[42:43], v[106:107]
    v_pk_add_f32 v[44:45], v[44:45], v[108:109]
    v_pk_add_f32 v[46:47], v[46:47], v[110:111]
    v_pk_add_f32 v[40:41], v[40:41], v[88:89]
    v_pk_add_f32 v[42:43], v[42:43], v[90:91]
    v_pk_add_f32 v[44:45], v[44:45], v[92:93]
    v_pk_add_f32 v[46:47], v[46:47], v[94:95]
    v_pk_mul_f32 v[40:41], v[40:41], v[122:123] op_sel_hi:[1,0]
    v_pk_mul_f32 v[42:43], v[42:43], v[122:123] op_sel_hi:[1,0]
    v_pk_mul_f32 v[44:45], v[44:45], v[122:123] op_sel_hi:[1,0]
    v_pk_mul_f32 v[46:47], v[46:47], v[122:123] op_sel_hi:[1,0]
    v_cvt_pk_bf16_f32 v88, v40, v41
    v_cvt_pk_bf16_f32 v89, v42, v43
    v_cvt_pk_bf16_f32 v90, v44, v45
    v_cvt_pk_bf16_f32 v91, v46, v47
    buffer_store_dwordx4 v[88:91], v4, s[48:51], s70 offen sc1
    s_waitcnt vmcnt(0)
    s_mov_b64 exec, 1
    ds_inc_u32 v0, v7 offset:24
    s_mov_b64 exec, -1
    s_or_b32 s68, s2, s3
    s_cmp_lg_u32 s68, 0
    s_cbranch_scc1 L_noep
    s_add_u32 s68, s66, 1
    v_mov_b32 v10, s68
    v_mov_b32 v11, 0
    s_mov_b64 exec, 1
    buffer_store_dword v10, v11, s[48:51], 0 offen
    s_mov_b64 exec, -1
L_noep:
L_fin:
L_end:
    s_endpgm
L_S2a:
    s_waitcnt vmcnt(0)
L_S2:
    s_load_dwordx2 s[20:21], s[0:1], 0
    s_load_dwordx2 s[24:25], s[0:1], 24
    s_load_dwordx2 s[28:29], s[0:1], 32
    s_load_dwordx2 s[32:33], s[0:1], 40
    s_load_dwordx2 s[36:37], s[0:1], 48
    s_load_dwordx2 s[40:41], s[0:1], 104
    s_load_dwordx2 s[52:53], s[0:1], 128
    s_load_dwordx2 s[44:45], s[0:1], 112
    s_mov_b32 s50, 33554432
    s_mov_b32 s51, 0x20000
    s_mov_b32 s46, 262144
    s_mov_b32 s47, 0x20000
    s_and_b32 s76, s3, 1
    s_bfe_u32 s77, s3, 0x10001
    s_lshl_b32 s7, s4, 3
    s_add_u32 s7, s7, s5
    s_mov_b32 s67, 0
    s_lshl_b32 s82, s4, 1
    s_add_u32 s82, s82, s76
    s_lshl_b32 s82, s82, 15
    s_add_u32 s82, s82, 1048576
    s_mov_b32 s22, 65536
    s_mov_b32 s23, 0x20000
    s_mov_b32 s26, 65536
    s_mov_b32 s27, 0x20000
    s_mov_b32 s30, 65536
    s_mov_b32 s31, 0x20000
    s_mov_b32 s34, 65536
    s_mov_b32 s35, 0x20000
    s_mov_b32 s38, 65536
    s_mov_b32 s39, 0x20000
    s_mov_b32 s42, 523392
    s_mov_b32 s43, 0x20000
    s_mov_b32 s54, 294912
    s_mov_b32 s55, 0x20000
    s_lshl_b32 s71, s5, 7
    s_lshl_b32 s72, s5, 16
    s_waitcnt lgkmcnt(0)
    s_mov_b64 s[56:57], s[24:25]
    s_mov_b64 s[58:59], s[28:29]
    s_mov_b64 s[60:61], s[32:33]
    s_mov_b64 s[62:63], s[36:37]
    s_mov_b64 s[64:65], s[40:41]
    s_add_u32 s20, s20, s70
    s_addc_u32 s21, s21, 0
    s_add_u32 s24, s24, s72
    s_addc_u32 s25, s25, 0
    s_add_u32 s28, s28, s72
    s_addc_u32 s29, s29, 0
    s_add_u32 s32, s32, s72
    s_addc_u32 s33, s33, 0
    s_add_u32 s36, s36, s72
    s_addc_u32 s37, s37, 0
    s_add_u32 s40, s40, s71
    s_addc_u32 s41, s41, 0
    s_add_u32 s52, s52, 196608
    s_addc_u32 s53, s53, 0
    s_lshl_b32 s68, s4, 18
    s_add_u32 s44, s44, s68
    s_addc_u32 s45, s45, 0
    s_add_u32 s80, s4, s5
    s_and_b32 s80, s80, 3
    v_lshrrev_b32 v20, 4, v1
    v_and_b32 v21, 15, v1
    v_lshlrev_b32 v22, 4, v21
    v_lshl_add_u32 v6, v20, 14, v22
    v_lshrrev_b32 v23, 1, v20
    v_and_b32 v24, 1, v20
    v_lshlrev_b32 v23, 15, v23
    v_lshl_add_u32 v23, v24, 12, v23
    v_add_u32 v5, v23, v22
    v_lshlrev_b32 v15, 7, v21
    s_lshl_b32 s68, s2, 11
    v_add_u32 v15, s68, v15
    s_mov_b32 s68, 1069066811
    v_lshlrev_b32 v100, 16, v100
    v_lshlrev_b32 v101, 16, v101
    v_lshlrev_b32 v102, 16, v102
    v_mul_f32 v102, s68, v102
    v_exp_f32 v102, v102
    s_nop 0
    v_cvt_pk_bf16_f32 v102, v102, v102
    v_and_b32 v102, 0xffff0000, v102
    v_mul_f32 v96, v102, v100
    v_mul_f32 v97, v102, v101
    v_mul_f32 v96, s68, v96
    v_exp_f32 v96, v96
    v_mul_f32 v97, 0.15915494, v97
    v_fract_f32 v97, v97
    v_cos_f32 v112, v97
    v_sin_f32 v113, v97
    s_nop 0
    v_mul_f32 v112, v96, v112
    v_mul_f32 v113, v96, v113
    v_mul_f32 v102, v100, v100
    v_fmac_f32 v102, v101, v101
    v_rcp_f32 v102, v102
    v_add_f32 v96, -1.0, v112
    v_mul_f32 v97, v96, v100
    v_fmac_f32 v97, v113, v101
    v_mul_f32 v98, v113, v100
    v_fma_f32 v98, -v96, v101, v98
    v_add_f32 v102, v102, v102
    v_mul_f32 v122, v97, v102
    v_mul_f32 v123, v98, v102
    v_mul_f32 v100, v113, v113
    v_mul_f32 v101, v112, v113
    v_fma_f32 v114, v112, v112, -v100
    v_add_f32 v115, v101, v101
    v_mul_f32 v100, v115, v115
    v_mul_f32 v101, v114, v115
    v_fma_f32 v114, v114, v114, -v100
    v_add_f32 v115, v101, v101
    v_mul_f32 v100, v115, v115
    v_mul_f32 v101, v114, v115
    v_fma_f32 v114, v114, v114, -v100
    v_add_f32 v115, v101, v101
    v_mul_f32 v100, v115, v115
    v_mul_f32 v101, v114, v115
    v_fma_f32 v116, v114, v114, -v100
    v_add_f32 v117, v101, v101
    v_mul_f32 v100, v117, v117
    v_mul_f32 v101, v116, v117
    v_fma_f32 v118, v116, v116, -v100
    v_add_f32 v119, v101, v101
    v_mul_f32 v100, v119, v119
    v_mul_f32 v101, v118, v119
    v_fma_f32 v118, v118, v118, -v100
    v_add_f32 v119, v101, v101
    v_mul_f32 v100, v119, v119
    v_mul_f32 v101, v118, v119
    v_fma_f32 v120, v118, v118, -v100
    v_add_f32 v121, v101, v101
    v_mul_f32 v100, v121, v121
    v_mul_f32 v101, v120, v121
    v_fma_f32 v120, v120, v120, -v100
    v_add_f32 v121, v101, v101
    v_mul_f32 v100, v121, v121
    v_mul_f32 v101, v120, v121
    v_fma_f32 v120, v120, v120, -v100
    v_add_f32 v121, v101, v101
    v_and_b32 v20, 1, v2
    v_lshlrev_b32 v20, 4, v20
    v_lshlrev_b32 v103, v20, v103
    v_bfe_u32 v20, v2, 3, 1
    v_cmp_eq_u32 vcc, v20, v3
    v_bfe_u32 v21, v2, 1, 2
    v_lshrrev_b32 v22, 4, v2
    v_cndmask_b32 v103, 0, v103, vcc
    v_lshl_add_u32 v21, v22, 2, v21
    v_cmp_eq_u32 vcc, 0, v21
    s_nop 1
    v_cndmask_b32 v104, 0, v103, vcc
    v_cmp_eq_u32 vcc, 1, v21
    s_nop 1
    v_cndmask_b32 v105, 0, v103, vcc
    v_cmp_eq_u32 vcc, 2, v21
    s_nop 1
    v_cndmask_b32 v106, 0, v103, vcc
    v_cmp_eq_u32 vcc, 3, v21
    s_nop 1
    v_cndmask_b32 v107, 0, v103, vcc
    v_cmp_eq_u32 vcc, 4, v21
    s_nop 1
    v_cndmask_b32 v108, 0, v103, vcc
    v_cmp_eq_u32 vcc, 5, v21
    s_nop 1
    v_cndmask_b32 v109, 0, v103, vcc
    v_cmp_eq_u32 vcc, 6, v21
    s_nop 1
    v_cndmask_b32 v110, 0, v103, vcc
    v_cmp_eq_u32 vcc, 7, v21
    s_nop 1
    v_cndmask_b32 v111, 0, v103, vcc
    v_and_b32 v20, 15, v2
    v_mul_u32_u24 v20, 1040, v20
    v_lshl_add_u32 v20, v3, 4, v20
    v_lshrrev_b32 v21, 4, v2
    v_lshl_add_u32 v20, v21, 8, v20
    s_lshl_b32 s68, s76, 9
    v_add_u32 v9, s68, v20
    v_add_u32 v10, 49920, v9
    s_lshl_b32 s68, s77, 9
    s_add_u32 s68, s68, 16640
    v_add_u32 v12, s68, v20
    v_add_u32 v13, 49920, v12
    v_bfe_u32 v20, v2, 2, 1
    v_lshlrev_b32 v20, 3, v20
    v_bfe_u32 v21, v2, 4, 1
    v_lshl_add_u32 v20, v21, 2, v20
    v_and_b32 v21, 3, v2
    v_add_u32 v20, v20, v21
    v_mul_u32_u24 v20, 1040, v20
    v_bfe_u32 v21, v2, 3, 1
    v_lshl_add_u32 v20, v21, 8, v20
    v_lshl_add_u32 v20, v3, 4, v20
    s_lshl_b32 s68, s76, 9
    s_and_b32 s69, s5, 1
    s_lshl_b32 s69, s69, 7
    s_add_u32 s68, s68, s69
    s_lshl_b32 s69, s77, 6
    s_add_u32 s68, s68, s69
    s_lshr_b32 s78, s5, 1
    s_sub_u32 s78, s78, s80
    s_and_b32 s78, s78, 3
    s_mul_i32 s69, s78, 49920
    s_cmp_eq_u32 s78, 3
    s_cselect_b32 s69, 0, s69
    s_add_u32 s68, s68, s69
    v_add_u32 v7, s68, v20
    s_mul_i32 s83, s81, 4160
    v_add_u32 v11, 99840, v9
    v_add_u32 v14, 99840, v12
    s_mov_b32 s75, 0
    L_sy_25:
    ds_read_b32 v125, v0 offset:0
    s_add_u32 s75, s75, 1
    s_waitcnt lgkmcnt(0)
    v_readfirstlane_b32 s68, v125
    s_cmp_ge_u32 s68, 6
    s_cbranch_scc1 L_syd_26
    s_sleep 1
    s_cmp_lt_u32 s75, 200000
    s_cbranch_scc1 L_sy_25
    L_syd_26:
    s_mov_b32 s75, 0
    L_sy_27:
    ds_read_b32 v125, v0 offset:12
    s_add_u32 s75, s75, 1
    s_waitcnt lgkmcnt(0)
    v_readfirstlane_b32 s68, v125
    s_cmp_ge_u32 s68, 4
    s_cbranch_scc1 L_syd_28
    s_sleep 1
    s_cmp_lt_u32 s75, 200000
    s_cbranch_scc1 L_sy_27
    L_syd_28:
    s_mov_b32 s75, 0
    L_sy_29:
    ds_read_b32 v125, v0 offset:4
    s_add_u32 s75, s75, 1
    s_waitcnt lgkmcnt(0)
    v_readfirstlane_b32 s68, v125
    s_cmp_ge_u32 s68, 12
    s_cbranch_scc1 L_syd_30
    s_cmp_lt_u32 s75, 200000
    s_cbranch_scc1 L_sy_29
    L_syd_30:
    s_setprio 0
    s_add_u32 s73, s80, 0
    s_and_b32 s73, s73, 3
    s_lshl_b32 s73, s73, 8
    s_lshl_b32 s71, s81, 12
    s_add_u32 s71, s71, s73
    s_lshl_b32 s72, s76, 14
    s_add_u32 s72, s72, s73
    s_lshl_b32 s73, s77, 11
    s_add_u32 s72, s72, s73
    s_add_u32 s73, s72, 8192
    s_add_u32 m0, s83, 0
    s_nop 0
    buffer_load_dwordx4 v5, s[20:23], s72 offen offset:0 lds
    s_waitcnt vmcnt(8)
    s_add_u32 m0, s83, 16640
    s_nop 0
    buffer_load_dwordx4 v6, s[24:27], s71 offen offset:0 lds
    s_waitcnt vmcnt(8)
    s_add_u32 m0, s83, 33280
    s_nop 0
    buffer_load_dwordx4 v6, s[28:31], s71 offen offset:0 lds
    s_waitcnt vmcnt(8)
    s_add_u32 m0, s83, 1040
    s_nop 0
    buffer_load_dwordx4 v5, s[20:23], s73 offen offset:0 lds
    s_waitcnt vmcnt(8)
    s_add_u32 m0, s83, 16656
    s_nop 0
    buffer_load_dwordx4 v6, s[24:27], s71 offen offset:1024 lds
    s_waitcnt vmcnt(8)
    s_add_u32 m0, s83, 33296
    s_nop 0
    buffer_load_dwordx4 v6, s[28:31], s71 offen offset:1024 lds
    s_waitcnt vmcnt(8)
    s_add_u32 m0, s83, 1056
    s_nop 0
    buffer_load_dwordx4 v5, s[20:23], s72 offen offset:1024 lds
    s_waitcnt vmcnt(8)
    s_add_u32 m0, s83, 16672
    s_nop 0
    buffer_load_dwordx4 v6, s[24:27], s71 offen offset:2048 lds
    s_waitcnt vmcnt(8)
    s_add_u32 m0, s83, 33312
    s_nop 0
    buffer_load_dwordx4 v6, s[28:31], s71 offen offset:2048 lds
    s_waitcnt vmcnt(8)
    s_add_u32 m0, s83, 2096
    s_nop 0
    buffer_load_dwordx4 v5, s[20:23], s73 offen offset:1024 lds
    s_waitcnt vmcnt(8)
    s_add_u32 m0, s83, 16688
    s_nop 0
    buffer_load_dwordx4 v6, s[24:27], s71 offen offset:3072 lds
    s_waitcnt vmcnt(8)
    s_add_u32 m0, s83, 33328
    s_nop 0
    buffer_load_dwordx4 v6, s[28:31], s71 offen offset:3072 lds
    s_waitcnt vmcnt(8)
    s_add_u32 s73, s80, 1
    s_and_b32 s73, s73, 3
    s_lshl_b32 s73, s73, 8
    s_lshl_b32 s71, s81, 12
    s_add_u32 s71, s71, s73
    s_lshl_b32 s72, s76, 14
    s_add_u32 s72, s72, s73
    s_lshl_b32 s73, s77, 11
    s_add_u32 s72, s72, s73
    s_add_u32 s73, s72, 8192
    s_add_u32 m0, s83, 49920
    s_nop 0
    buffer_load_dwordx4 v5, s[20:23], s72 offen offset:0 lds
    s_waitcnt vmcnt(8)
    s_add_u32 m0, s83, 66560
    s_nop 0
    buffer_load_dwordx4 v6, s[24:27], s71 offen offset:0 lds
    s_waitcnt vmcnt(8)
    s_add_u32 m0, s83, 83200
    s_nop 0
    buffer_load_dwordx4 v6, s[28:31], s71 offen offset:0 lds
    s_waitcnt vmcnt(8)
    s_waitcnt vmcnt(3)
    s_setprio 3
    s_mov_b64 exec, 1
    ds_add_u32 v0, v124 offset:0
    s_mov_b64 exec, -1
    s_mov_b32 s75, 0
    L_sy_31:
    ds_read_b32 v125, v0 offset:0
    s_add_u32 s75, s75, 1
    s_waitcnt lgkmcnt(0)
    v_readfirstlane_b32 s68, v125
    s_cmp_ge_u32 s68, 10
    s_cbranch_scc1 L_syd_32
    s_cmp_lt_u32 s75, 200000
    s_cbranch_scc1 L_sy_31
    L_syd_32:
    s_setprio 0
    s_cmp_lg_u32 s78, 0
    s_cbranch_scc1 L_nod_33
    ds_read_b128 v[64:67], v7
    ds_read_b128 v[68:71], v7 offset:32
    s_waitcnt lgkmcnt(0)
    v_mfma_f32_32x32x16_bf16 v[48:63], v[64:67], v[104:107], 0
    v_mfma_f32_32x32x16_bf16 v[48:63], v[68:71], v[108:111], v[48:63]
    L_nod_33:
    ds_read_b128 v[80:83], v9 offset:0
    ds_read_b128 v[84:87], v12 offset:0
    ds_read_b128 v[88:91], v12 offset:16640
    ds_read_b128 v[92:95], v9 offset:32
    ds_read_b128 v[96:99], v12 offset:32
    ds_read_b128 v[100:103], v12 offset:16672
    ds_read_b128 v[64:67], v9 offset:64
    ds_read_b128 v[68:71], v12 offset:64
    ds_read_b128 v[72:75], v12 offset:16704
    s_waitcnt lgkmcnt(6)
    v_mfma_f32_32x32x16_bf16 v[16:31], v[80:83], v[84:87], 0
    s_add_u32 m0, s83, 50960
    s_nop 0
    buffer_load_dwordx4 v5, s[20:23], s73 offen offset:0 lds
    s_waitcnt vmcnt(6)
    s_add_u32 m0, s83, 66576
    s_nop 0
    buffer_load_dwordx4 v6, s[24:27], s71 offen offset:1024 lds
    s_waitcnt vmcnt(6)
    s_add_u32 m0, s83, 83216
    s_nop 0
    buffer_load_dwordx4 v6, s[28:31], s71 offen offset:1024 lds
    s_waitcnt vmcnt(6)
    v_mfma_f32_32x32x16_bf16 v[32:47], v[80:83], v[88:91], 0
    ds_read_b128 v[80:83], v9 offset:96
    ds_read_b128 v[84:87], v12 offset:96
    ds_read_b128 v[88:91], v12 offset:16736
    s_waitcnt lgkmcnt(6)
    v_mfma_f32_32x32x16_bf16 v[16:31], v[92:95], v[96:99], v[16:31]
    s_add_u32 m0, s83, 50976
    s_nop 0
    buffer_load_dwordx4 v5, s[20:23], s72 offen offset:1024 lds
    s_waitcnt vmcnt(6)
    s_add_u32 m0, s83, 66592
    s_nop 0
    buffer_load_dwordx4 v6, s[24:27], s71 offen offset:2048 lds
    s_waitcnt vmcnt(6)
    v_mfma_f32_32x32x16_bf16 v[32:47], v[92:95], v[100:103], v[32:47]
    ds_read_b128 v[92:95], v9 offset:128
    ds_read_b128 v[96:99], v12 offset:128
    ds_read_b128 v[100:103], v12 offset:16768
    s_waitcnt lgkmcnt(6)
    v_mfma_f32_32x32x16_bf16 v[16:31], v[64:67], v[68:71], v[16:31]
    s_add_u32 m0, s83, 83232
    s_nop 0
    buffer_load_dwordx4 v6, s[28:31], s71 offen offset:2048 lds
    s_waitcnt vmcnt(6)
    s_add_u32 m0, s83, 52016
    s_nop 0
    buffer_load_dwordx4 v5, s[20:23], s73 offen offset:1024 lds
    s_waitcnt vmcnt(6)
    v_mfma_f32_32x32x16_bf16 v[32:47], v[64:67], v[72:75], v[32:47]
    ds_read_b128 v[64:67], v9 offset:160
    ds_read_b128 v[68:71], v12 offset:160
    ds_read_b128 v[72:75], v12 offset:16800
    s_waitcnt lgkmcnt(6)
    v_mfma_f32_32x32x16_bf16 v[16:31], v[80:83], v[84:87], v[16:31]
    s_add_u32 m0, s83, 66608
    s_nop 0
    buffer_load_dwordx4 v6, s[24:27], s71 offen offset:3072 lds
    s_waitcnt vmcnt(6)
    s_add_u32 m0, s83, 83248
    s_nop 0
    buffer_load_dwordx4 v6, s[28:31], s71 offen offset:3072 lds
    s_waitcnt vmcnt(6)
    v_mfma_f32_32x32x16_bf16 v[32:47], v[80:83], v[88:91], v[32:47]
    ds_read_b128 v[80:83], v9 offset:192
    ds_read_b128 v[84:87], v12 offset:192
    ds_read_b128 v[88:91], v12 offset:16832
    s_waitcnt lgkmcnt(6)
    v_mfma_f32_32x32x16_bf16 v[16:31], v[92:95], v[96:99], v[16:31]
    s_add_u32 s73, s80, 2
    s_and_b32 s73, s73, 3
    s_lshl_b32 s73, s73, 8
    s_lshl_b32 s71, s81, 12
    s_add_u32 s71, s71, s73
    s_lshl_b32 s72, s76, 14
    s_add_u32 s72, s72, s73
    s_lshl_b32 s73, s77, 11
    s_add_u32 s72, s72, s73
    s_add_u32 s73, s72, 8192
    s_add_u32 m0, s83, 99840
    s_nop 0
    buffer_load_dwordx4 v5, s[20:23], s72 offen offset:0 lds
    s_waitcnt vmcnt(6)
    s_add_u32 m0, s83, 116480
    s_nop 0
    buffer_load_dwordx4 v6, s[24:27], s71 offen offset:0 lds
    s_waitcnt vmcnt(6)
    v_mfma_f32_32x32x16_bf16 v[32:47], v[92:95], v[100:103], v[32:47]
    ds_read_b128 v[92:95], v9 offset:224
    ds_read_b128 v[96:99], v12 offset:224
    ds_read_b128 v[100:103], v12 offset:16864
    s_waitcnt lgkmcnt(6)
    v_mfma_f32_32x32x16_bf16 v[16:31], v[64:67], v[68:71], v[16:31]
    s_add_u32 m0, s83, 133120
    s_nop 0
    buffer_load_dwordx4 v6, s[28:31], s71 offen offset:0 lds
    s_waitcnt vmcnt(6)
    s_add_u32 m0, s83, 100880
    s_nop 0
    buffer_load_dwordx4 v5, s[20:23], s73 offen offset:0 lds
    s_waitcnt vmcnt(6)
    v_mfma_f32_32x32x16_bf16 v[32:47], v[64:67], v[72:75], v[32:47]
    s_waitcnt lgkmcnt(3)
    v_mfma_f32_32x32x16_bf16 v[16:31], v[80:83], v[84:87], v[16:31]
    s_add_u32 m0, s83, 116496
    s_nop 0
    buffer_load_dwordx4 v6, s[24:27], s71 offen offset:1024 lds
    s_waitcnt vmcnt(6)
    s_add_u32 m0, s83, 133136
    s_nop 0
    buffer_load_dwordx4 v6, s[28:31], s71 offen offset:1024 lds
    s_waitcnt vmcnt(6)
    v_mfma_f32_32x32x16_bf16 v[32:47], v[80:83], v[88:91], v[32:47]
    s_waitcnt lgkmcnt(0)
    s_waitcnt vmcnt(6)
    s_mov_b64 exec, 1
    ds_add_u32 v0, v124 offset:0
    s_mov_b64 exec, -1
    v_mfma_f32_32x32x16_bf16 v[16:31], v[92:95], v[96:99], v[16:31]
    v_mfma_f32_32x32x16_bf16 v[32:47], v[92:95], v[100:103], v[32:47]
    s_setprio 3
    s_cmp_lg_u32 s81, 1
    s_cbranch_scc1 L_pfx_34
    s_and_b32 s68, s4, 7
    s_lshl_b32 s68, s68, 16
    v_lshlrev_b32 v15, 10, v1
    buffer_load_dword v127, v15, s[40:43], s68 offen
L_pfx_34:
    s_mov_b32 s75, 0
    L_sy_35:
    ds_read_b32 v125, v0 offset:0
    s_add_u32 s75, s75, 1
    s_waitcnt lgkmcnt(0)
    v_readfirstlane_b32 s68, v125
    s_cmp_ge_u32 s68, 14
    s_cbranch_scc1 L_syd_36
    s_cmp_lt_u32 s75, 200000
    s_cbranch_scc1 L_sy_35
    L_syd_36:
    s_setprio 0
    s_cmp_lg_u32 s78, 1
    s_cbranch_scc1 L_nod_37
    ds_read_b128 v[64:67], v7
    ds_read_b128 v[68:71], v7 offset:32
    s_waitcnt lgkmcnt(0)
    v_mfma_f32_32x32x16_bf16 v[48:63], v[64:67], v[104:107], 0
    v_mfma_f32_32x32x16_bf16 v[48:63], v[68:71], v[108:111], v[48:63]
    L_nod_37:
    ds_read_b128 v[80:83], v10 offset:0
    ds_read_b128 v[84:87], v13 offset:0
    ds_read_b128 v[88:91], v13 offset:16640
    ds_read_b128 v[92:95], v10 offset:32
    ds_read_b128 v[96:99], v13 offset:32
    ds_read_b128 v[100:103], v13 offset:16672
    ds_read_b128 v[64:67], v10 offset:64
    ds_read_b128 v[68:71], v13 offset:64
    ds_read_b128 v[72:75], v13 offset:16704
    s_waitcnt lgkmcnt(6)
    v_mfma_f32_32x32x16_bf16 v[16:31], v[80:83], v[84:87], v[16:31]
    s_add_u32 m0, s83, 100896
    s_nop 0
    buffer_load_dwordx4 v5, s[20:23], s72 offen offset:1024 lds
    s_waitcnt vmcnt(6)
    s_add_u32 m0, s83, 116512
    s_nop 0
    buffer_load_dwordx4 v6, s[24:27], s71 offen offset:2048 lds
    s_waitcnt vmcnt(6)
    s_add_u32 m0, s83, 133152
    s_nop 0
    buffer_load_dwordx4 v6, s[28:31], s71 offen offset:2048 lds
    s_waitcnt vmcnt(6)
    v_mfma_f32_32x32x16_bf16 v[32:47], v[80:83], v[88:91], v[32:47]
    ds_read_b128 v[80:83], v10 offset:96
    ds_read_b128 v[84:87], v13 offset:96
    ds_read_b128 v[88:91], v13 offset:16736
    s_waitcnt lgkmcnt(6)
    v_mfma_f32_32x32x16_bf16 v[16:31], v[92:95], v[96:99], v[16:31]
    s_add_u32 m0, s83, 101936
    s_nop 0
    buffer_load_dwordx4 v5, s[20:23], s73 offen offset:1024 lds
    s_waitcnt vmcnt(6)
    s_add_u32 m0, s83, 116528
    s_nop 0
    buffer_load_dwordx4 v6, s[24:27], s71 offen offset:3072 lds
    s_waitcnt vmcnt(6)
    s_add_u32 m0, s83, 133168
    s_nop 0
    buffer_load_dwordx4 v6, s[28:31], s71 offen offset:3072 lds
    s_waitcnt vmcnt(6)
    v_mfma_f32_32x32x16_bf16 v[32:47], v[92:95], v[100:103], v[32:47]
    ds_read_b128 v[92:95], v10 offset:128
    ds_read_b128 v[96:99], v13 offset:128
    ds_read_b128 v[100:103], v13 offset:16768
    s_waitcnt lgkmcnt(6)
    v_mfma_f32_32x32x16_bf16 v[16:31], v[64:67], v[68:71], v[16:31]
    s_add_u32 s73, s80, 3
    s_and_b32 s73, s73, 3
    s_lshl_b32 s73, s73, 8
    s_lshl_b32 s71, s81, 12
    s_add_u32 s71, s71, s73
    s_lshl_b32 s72, s76, 14
    s_add_u32 s72, s72, s73
    s_lshl_b32 s73, s77, 11
    s_add_u32 s72, s72, s73
    s_add_u32 s73, s72, 8192
    s_add_u32 m0, s83, 0
    s_nop 0
    buffer_load_dwordx4 v5, s[20:23], s72 offen offset:0 lds
    s_waitcnt vmcnt(6)
    s_add_u32 m0, s83, 16640
    s_nop 0
    buffer_load_dwordx4 v6, s[24:27], s71 offen offset:0 lds
    s_waitcnt vmcnt(6)
    s_add_u32 m0, s83, 33280
    s_nop 0
    buffer_load_dwordx4 v6, s[28:31], s71 offen offset:0 lds
    s_waitcnt vmcnt(6)
    v_mfma_f32_32x32x16_bf16 v[32:47], v[64:67], v[72:75], v[32:47]
    ds_read_b128 v[64:67], v10 offset:160
    ds_read_b128 v[68:71], v13 offset:160
    ds_read_b128 v[72:75], v13 offset:16800
    s_waitcnt lgkmcnt(6)
    v_mfma_f32_32x32x16_bf16 v[16:31], v[80:83], v[84:87], v[16:31]
    s_add_u32 m0, s83, 1040
    s_nop 0
    buffer_load_dwordx4 v5, s[20:23], s73 offen offset:0 lds
    s_waitcnt vmcnt(6)
    s_add_u32 m0, s83, 16656
    s_nop 0
    buffer_load_dwordx4 v6, s[24:27], s71 offen offset:1024 lds
    s_waitcnt vmcnt(6)
    s_add_u32 m0, s83, 33296
    s_nop 0
    buffer_load_dwordx4 v6, s[28:31], s71 offen offset:1024 lds
    s_waitcnt vmcnt(6)
    v_mfma_f32_32x32x16_bf16 v[32:47], v[80:83], v[88:91], v[32:47]
    ds_read_b128 v[80:83], v10 offset:192
    ds_read_b128 v[84:87], v13 offset:192
    ds_read_b128 v[88:91], v13 offset:16832
    s_waitcnt lgkmcnt(6)
    v_mfma_f32_32x32x16_bf16 v[16:31], v[92:95], v[96:99], v[16:31]
    s_add_u32 m0, s83, 1056
    s_nop 0
    buffer_load_dwordx4 v5, s[20:23], s72 offen offset:1024 lds
    s_waitcnt vmcnt(6)
    s_add_u32 m0, s83, 16672
    s_nop 0
    buffer_load_dwordx4 v6, s[24:27], s71 offen offset:2048 lds
    s_waitcnt vmcnt(6)
    v_mfma_f32_32x32x16_bf16 v[32:47], v[92:95], v[100:103], v[32:47]
    ds_read_b128 v[92:95], v10 offset:224
    ds_read_b128 v[96:99], v13 offset:224
    ds_read_b128 v[100:103], v13 offset:16864
    s_waitcnt lgkmcnt(6)
    v_mfma_f32_32x32x16_bf16 v[16:31], v[64:67], v[68:71], v[16:31]
    s_add_u32 m0, s83, 33312
    s_nop 0
    buffer_load_dwordx4 v6, s[28:31], s71 offen offset:2048 lds
    s_waitcnt vmcnt(6)
    s_add_u32 m0, s83, 2096
    s_nop 0
    buffer_load_dwordx4 v5, s[20:23], s73 offen offset:1024 lds
    s_waitcnt vmcnt(6)
    v_mfma_f32_32x32x16_bf16 v[32:47], v[64:67], v[72:75], v[32:47]
    s_waitcnt lgkmcnt(3)
    v_mfma_f32_32x32x16_bf16 v[16:31], v[80:83], v[84:87], v[16:31]
    s_add_u32 m0, s83, 16688
    s_nop 0
    buffer_load_dwordx4 v6, s[24:27], s71 offen offset:3072 lds
    s_waitcnt vmcnt(6)
    s_add_u32 m0, s83, 33328
    s_nop 0
    buffer_load_dwordx4 v6, s[28:31], s71 offen offset:3072 lds
    s_waitcnt vmcnt(6)
    v_mfma_f32_32x32x16_bf16 v[32:47], v[80:83], v[88:91], v[32:47]
    s_waitcnt lgkmcnt(0)
    s_waitcnt vmcnt(12)
    s_mov_b64 exec, 1
    ds_add_u32 v0, v124 offset:0
    s_mov_b64 exec, -1
    v_mfma_f32_32x32x16_bf16 v[16:31], v[92:95], v[96:99], v[16:31]
    v_mfma_f32_32x32x16_bf16 v[32:47], v[92:95], v[100:103], v[32:47]
    s_setprio 3
    v_mov_b32 v64, -1
    v_mov_b32 v65, -1
    v_mov_b32 v66, -1
    v_mov_b32 v67, -1
    s_lshl_b32 s68, s5, 12
    s_add_u32 s68, s68, s82
    s_lshl_b32 s69, s77, 11
    s_add_u32 s68, s68, s69
    buffer_store_dwordx4 v[64:67], v4, s[48:51], s68 offen sc1
    buffer_store_dwordx4 v[64:67], v4, s[48:51], s68 offen offset:1024 sc1
    v_mov_b32 v68, 0
    v_mov_b32 v69, s6
    v_mov_b32 v70, 0
    v_mov_b32 v71, s6
    s_lshl_b32 s69, s7, 7
    s_add_u32 s69, s69, 262144
    s_mov_b64 exec, 1
    buffer_store_dwordx4 v[68:71], v68, s[52:55], s69 offen sc1
    s_mov_b64 exec, -1
    s_mov_b32 s75, 0
    L_sy_38:
    ds_read_b32 v125, v0 offset:0
    s_add_u32 s75, s75, 1
    s_waitcnt lgkmcnt(0)
    v_readfirstlane_b32 s68, v125
    s_cmp_ge_u32 s68, 18
    s_cbranch_scc1 L_syd_39
    s_cmp_lt_u32 s75, 200000
    s_cbranch_scc1 L_sy_38
    L_syd_39:
    s_setprio 0
    s_cmp_lg_u32 s78, 2
    s_cbranch_scc1 L_nod_40
    ds_read_b128 v[64:67], v7
    ds_read_b128 v[68:71], v7 offset:32
    s_waitcnt lgkmcnt(0)
    v_mfma_f32_32x32x16_bf16 v[48:63], v[64:67], v[104:107], 0
    v_mfma_f32_32x32x16_bf16 v[48:63], v[68:71], v[108:111], v[48:63]
    L_nod_40:
    ds_read_b128 v[80:83], v11 offset:0
    ds_read_b128 v[84:87], v14 offset:0
    ds_read_b128 v[88:91], v14 offset:16640
    ds_read_b128 v[92:95], v11 offset:32
    ds_read_b128 v[96:99], v14 offset:32
    ds_read_b128 v[100:103], v14 offset:16672
    ds_read_b128 v[64:67], v11 offset:64
    ds_read_b128 v[68:71], v14 offset:64
    ds_read_b128 v[72:75], v14 offset:16704
    s_waitcnt lgkmcnt(6)
    v_mfma_f32_32x32x16_bf16 v[16:31], v[80:83], v[84:87], v[16:31]
    v_mfma_f32_32x32x16_bf16 v[32:47], v[80:83], v[88:91], v[32:47]
    ds_read_b128 v[80:83], v11 offset:96
    ds_read_b128 v[84:87], v14 offset:96
    ds_read_b128 v[88:91], v14 offset:16736
    s_waitcnt lgkmcnt(6)
    v_mfma_f32_32x32x16_bf16 v[16:31], v[92:95], v[96:99], v[16:31]
    v_mfma_f32_32x32x16_bf16 v[32:47], v[92:95], v[100:103], v[32:47]
    ds_read_b128 v[92:95], v11 offset:128
    ds_read_b128 v[96:99], v14 offset:128
    ds_read_b128 v[100:103], v14 offset:16768
    s_waitcnt lgkmcnt(6)
    v_mfma_f32_32x32x16_bf16 v[16:31], v[64:67], v[68:71], v[16:31]
    v_mfma_f32_32x32x16_bf16 v[32:47], v[64:67], v[72:75], v[32:47]
    ds_read_b128 v[64:67], v11 offset:160
    ds_read_b128 v[68:71], v14 offset:160
    ds_read_b128 v[72:75], v14 offset:16800
    s_waitcnt lgkmcnt(6)
    v_mfma_f32_32x32x16_bf16 v[16:31], v[80:83], v[84:87], v[16:31]
    v_mfma_f32_32x32x16_bf16 v[32:47], v[80:83], v[88:91], v[32:47]
    ds_read_b128 v[80:83], v11 offset:192
    ds_read_b128 v[84:87], v14 offset:192
    ds_read_b128 v[88:91], v14 offset:16832
    s_waitcnt lgkmcnt(6)
    v_mfma_f32_32x32x16_bf16 v[16:31], v[92:95], v[96:99], v[16:31]
    v_mfma_f32_32x32x16_bf16 v[32:47], v[92:95], v[100:103], v[32:47]
    ds_read_b128 v[92:95], v11 offset:224
    ds_read_b128 v[96:99], v14 offset:224
    ds_read_b128 v[100:103], v14 offset:16864
    s_waitcnt lgkmcnt(6)
    v_mfma_f32_32x32x16_bf16 v[16:31], v[64:67], v[68:71], v[16:31]
    v_mfma_f32_32x32x16_bf16 v[32:47], v[64:67], v[72:75], v[32:47]
    s_waitcnt lgkmcnt(3)
    v_mfma_f32_32x32x16_bf16 v[16:31], v[80:83], v[84:87], v[16:31]
    v_mfma_f32_32x32x16_bf16 v[32:47], v[80:83], v[88:91], v[32:47]
    s_waitcnt lgkmcnt(0)
    s_waitcnt vmcnt(0)
    s_mov_b64 exec, 1
    ds_add_u32 v0, v124 offset:0
    s_mov_b64 exec, -1
    v_mfma_f32_32x32x16_bf16 v[16:31], v[92:95], v[96:99], v[16:31]
    v_mfma_f32_32x32x16_bf16 v[32:47], v[92:95], v[100:103], v[32:47]
    s_setprio 3
    s_cmp_lg_u32 s81, 2
    s_cbranch_scc1 L_pfx_41
    s_and_b32 s68, s4, 7
    s_lshl_b32 s68, s68, 13
    v_lshlrev_b32 v15, 7, v1
    buffer_load_dword v127, v15, s[32:35], s68 offen
L_pfx_41:
    s_cmp_lg_u32 s81, 3
    s_cbranch_scc1 L_pfx_42
    s_and_b32 s68, s4, 7
    s_lshl_b32 s68, s68, 13
    v_lshlrev_b32 v15, 7, v1
    buffer_load_dword v127, v15, s[36:39], s68 offen
L_pfx_42:
    v_lshrrev_b32 v6, 3, v1
    v_and_b32 v8, 7, v1
    v_bfe_u32 v15, v1, 4, 1
    v_lshlrev_b32 v15, 2, v15
    v_xor_b32 v8, v8, v15
    v_lshlrev_b32 v8, 4, v8
    v_lshl_add_u32 v5, v6, 10, v8
    s_mul_i32 s70, s81, 16640
    s_lshl_b32 s71, s81, 14
    s_lshl_b32 s74, s81, 17
    s_mov_b32 s75, 0
    L_sy_43:
    ds_read_b32 v125, v0 offset:0
    s_add_u32 s75, s75, 1
    s_waitcnt lgkmcnt(0)
    v_readfirstlane_b32 s68, v125
    s_cmp_ge_u32 s68, 22
    s_cbranch_scc1 L_syd_44
    s_cmp_lt_u32 s75, 200000
    s_cbranch_scc1 L_sy_43
    L_syd_44:
    s_setprio 0
    s_cmp_lg_u32 s78, 3
    s_cbranch_scc1 L_nod_45
    ds_read_b128 v[64:67], v7
    ds_read_b128 v[68:71], v7 offset:32
    s_waitcnt lgkmcnt(0)
    v_mfma_f32_32x32x16_bf16 v[48:63], v[64:67], v[104:107], 0
    v_mfma_f32_32x32x16_bf16 v[48:63], v[68:71], v[108:111], v[48:63]
    L_nod_45:
    ds_read_b128 v[80:83], v9 offset:0
    ds_read_b128 v[84:87], v12 offset:0
    ds_read_b128 v[88:91], v12 offset:16640
    ds_read_b128 v[92:95], v9 offset:32
    ds_read_b128 v[96:99], v12 offset:32
    ds_read_b128 v[100:103], v12 offset:16672
    ds_read_b128 v[64:67], v9 offset:64
    ds_read_b128 v[68:71], v12 offset:64
    ds_read_b128 v[72:75], v12 offset:16704
    s_waitcnt lgkmcnt(6)
    v_mfma_f32_32x32x16_bf16 v[16:31], v[80:83], v[84:87], v[16:31]
    s_add_u32 m0, s71, 66560
    s_add_u32 s69, s74, 0
    buffer_load_dwordx4 v5, s[40:43], s69 offen lds
    s_waitcnt vmcnt(6)
    s_add_u32 m0, s71, 67584
    s_add_u32 s69, s74, 8192
    buffer_load_dwordx4 v5, s[40:43], s69 offen lds
    s_waitcnt vmcnt(6)
    v_mfma_f32_32x32x16_bf16 v[32:47], v[80:83], v[88:91], v[32:47]
    ds_read_b128 v[80:83], v9 offset:96
    ds_read_b128 v[84:87], v12 offset:96
    ds_read_b128 v[88:91], v12 offset:16736
    s_waitcnt lgkmcnt(6)
    v_mfma_f32_32x32x16_bf16 v[16:31], v[92:95], v[96:99], v[16:31]
    s_add_u32 m0, s71, 68608
    s_add_u32 s69, s74, 16384
    buffer_load_dwordx4 v5, s[40:43], s69 offen lds
    s_waitcnt vmcnt(6)
    s_add_u32 m0, s71, 69632
    s_add_u32 s69, s74, 24576
    buffer_load_dwordx4 v5, s[40:43], s69 offen lds
    s_waitcnt vmcnt(6)
    v_mfma_f32_32x32x16_bf16 v[32:47], v[92:95], v[100:103], v[32:47]
    ds_read_b128 v[92:95], v9 offset:128
    ds_read_b128 v[96:99], v12 offset:128
    ds_read_b128 v[100:103], v12 offset:16768
    s_waitcnt lgkmcnt(6)
    v_mfma_f32_32x32x16_bf16 v[16:31], v[64:67], v[68:71], v[16:31]
    s_add_u32 m0, s71, 70656
    s_add_u32 s69, s74, 32768
    buffer_load_dwordx4 v5, s[40:43], s69 offen lds
    s_waitcnt vmcnt(6)
    s_add_u32 m0, s71, 71680
    s_add_u32 s69, s74, 40960
    buffer_load_dwordx4 v5, s[40:43], s69 offen lds
    s_waitcnt vmcnt(6)
    v_mfma_f32_32x32x16_bf16 v[32:47], v[64:67], v[72:75], v[32:47]
    ds_read_b128 v[64:67], v9 offset:160
    ds_read_b128 v[68:71], v12 offset:160
    ds_read_b128 v[72:75], v12 offset:16800
    s_waitcnt lgkmcnt(6)
    v_mfma_f32_32x32x16_bf16 v[16:31], v[80:83], v[84:87], v[16:31]
    s_add_u32 m0, s71, 72704
    s_add_u32 s69, s74, 49152
    buffer_load_dwordx4 v5, s[40:43], s69 offen lds
    s_waitcnt vmcnt(6)
    s_add_u32 m0, s71, 73728
    s_add_u32 s69, s74, 57344
    buffer_load_dwordx4 v5, s[40:43], s69 offen lds
    s_waitcnt vmcnt(6)
    v_mfma_f32_32x32x16_bf16 v[32:47], v[80:83], v[88:91], v[32:47]
    ds_read_b128 v[80:83], v9 offset:192
    ds_read_b128 v[84:87], v12 offset:192
    ds_read_b128 v[88:91], v12 offset:16832
    s_waitcnt lgkmcnt(6)
    v_mfma_f32_32x32x16_bf16 v[16:31], v[92:95], v[96:99], v[16:31]
    s_add_u32 m0, s71, 74752
    s_add_u32 s69, s74, 65536
    buffer_load_dwordx4 v5, s[40:43], s69 offen lds
    s_waitcnt vmcnt(6)
    s_add_u32 m0, s71, 75776
    s_add_u32 s69, s74, 73728
    buffer_load_dwordx4 v5, s[40:43], s69 offen lds
    s_waitcnt vmcnt(6)
    v_mfma_f32_32x32x16_bf16 v[32:47], v[92:95], v[100:103], v[32:47]
    ds_read_b128 v[92:95], v9 offset:224
    ds_read_b128 v[96:99], v12 offset:224
    ds_read_b128 v[100:103], v12 offset:16864
    s_waitcnt lgkmcnt(6)
    v_mfma_f32_32x32x16_bf16 v[16:31], v[64:67], v[68:71], v[16:31]
    s_add_u32 m0, s71, 76800
    s_add_u32 s69, s74, 81920
    buffer_load_dwordx4 v5, s[40:43], s69 offen lds
    s_waitcnt vmcnt(6)
    s_add_u32 m0, s71, 77824
    s_add_u32 s69, s74, 90112
    buffer_load_dwordx4 v5, s[40:43], s69 offen lds
    s_waitcnt vmcnt(6)
    v_mfma_f32_32x32x16_bf16 v[32:47], v[64:67], v[72:75], v[32:47]
    s_waitcnt lgkmcnt(3)
    v_mfma_f32_32x32x16_bf16 v[16:31], v[80:83], v[84:87], v[16:31]
    s_add_u32 m0, s71, 78848
    s_add_u32 s69, s74, 98304
    buffer_load_dwordx4 v5, s[40:43], s69 offen lds
    s_waitcnt vmcnt(6)
    s_add_u32 m0, s71, 79872
    s_add_u32 s69, s74, 106496
    buffer_load_dwordx4 v5, s[40:43], s69 offen lds
    s_waitcnt vmcnt(6)
    v_mfma_f32_32x32x16_bf16 v[32:47], v[80:83], v[88:91], v[32:47]
    s_waitcnt lgkmcnt(0)
    v_mfma_f32_32x32x16_bf16 v[16:31], v[92:95], v[96:99], v[16:31]
    s_add_u32 m0, s71, 80896
    s_add_u32 s69, s74, 114688
    buffer_load_dwordx4 v5, s[40:43], s69 offen lds
    s_waitcnt vmcnt(6)
    s_add_u32 m0, s71, 81920
    s_add_u32 s69, s74, 122880
    buffer_load_dwordx4 v5, s[40:43], s69 offen lds
    s_waitcnt vmcnt(6)
    v_mfma_f32_32x32x16_bf16 v[32:47], v[92:95], v[100:103], v[32:47]
    s_setprio 3
    s_lshl_b32 s68, s76, 10
    s_lshl_b32 s69, s77, 8
    s_add_u32 s69, s69, 157952
    s_add_u32 s68, s68, s69
    v_lshlrev_b32 v10, 3, v2
    v_add_u32 v11, s69, v10
    v_lshl_add_u32 v10, v3, 9, v10
    v_add_u32 v10, s68, v10
    s_nop 3
    v_pk_fma_f32 v[84:85], v[112:113], v[16:17], v[18:19] op_sel_hi:[0,1,1]
    v_pk_fma_f32 v[86:87], v[112:113], v[32:33], v[34:35] op_sel_hi:[0,1,1]
    v_pk_fma_f32 v[6:7], v[112:113], v[32:33], v[84:85] op_sel:[1,0,0] neg_lo:[1,0,0] neg_hi:[1,0,0]
    v_pk_fma_f32 v[8:9], v[112:113], v[16:17], v[86:87] op_sel:[1,0,0]
    v_pk_fma_f32 v[84:85], v[112:113], v[6:7], v[20:21] op_sel_hi:[0,1,1]
    v_pk_fma_f32 v[86:87], v[112:113], v[8:9], v[36:37] op_sel_hi:[0,1,1]
    v_pk_fma_f32 v[80:81], v[112:113], v[8:9], v[84:85] op_sel:[1,0,0] neg_lo:[1,0,0] neg_hi:[1,0,0]
    v_pk_fma_f32 v[82:83], v[112:113], v[6:7], v[86:87] op_sel:[1,0,0]
    v_pk_fma_f32 v[84:85], v[112:113], v[80:81], v[22:23] op_sel_hi:[0,1,1]
    v_pk_fma_f32 v[86:87], v[112:113], v[82:83], v[38:39] op_sel_hi:[0,1,1]
    v_pk_fma_f32 v[6:7], v[112:113], v[82:83], v[84:85] op_sel:[1,0,0] neg_lo:[1,0,0] neg_hi:[1,0,0]
    v_pk_fma_f32 v[8:9], v[112:113], v[80:81], v[86:87] op_sel:[1,0,0]
    v_pk_fma_f32 v[84:85], v[112:113], v[6:7], v[24:25] op_sel_hi:[0,1,1]
    v_pk_fma_f32 v[86:87], v[112:113], v[8:9], v[40:41] op_sel_hi:[0,1,1]
    v_pk_fma_f32 v[80:81], v[112:113], v[8:9], v[84:85] op_sel:[1,0,0] neg_lo:[1,0,0] neg_hi:[1,0,0]
    v_pk_fma_f32 v[82:83], v[112:113], v[6:7], v[86:87] op_sel:[1,0,0]
    v_pk_fma_f32 v[84:85], v[112:113], v[80:81], v[26:27] op_sel_hi:[0,1,1]
    v_pk_fma_f32 v[86:87], v[112:113], v[82:83], v[42:43] op_sel_hi:[0,1,1]
    v_pk_fma_f32 v[6:7], v[112:113], v[82:83], v[84:85] op_sel:[1,0,0] neg_lo:[1,0,0] neg_hi:[1,0,0]
    v_pk_fma_f32 v[8:9], v[112:113], v[80:81], v[86:87] op_sel:[1,0,0]
    v_pk_fma_f32 v[84:85], v[112:113], v[6:7], v[28:29] op_sel_hi:[0,1,1]
    v_pk_fma_f32 v[86:87], v[112:113], v[8:9], v[44:45] op_sel_hi:[0,1,1]
    v_pk_fma_f32 v[80:81], v[112:113], v[8:9], v[84:85] op_sel:[1,0,0] neg_lo:[1,0,0] neg_hi:[1,0,0]
    v_pk_fma_f32 v[82:83], v[112:113], v[6:7], v[86:87] op_sel:[1,0,0]
    v_pk_fma_f32 v[84:85], v[112:113], v[80:81], v[30:31] op_sel_hi:[0,1,1]
    v_pk_fma_f32 v[86:87], v[112:113], v[82:83], v[46:47] op_sel_hi:[0,1,1]
    v_pk_fma_f32 v[6:7], v[112:113], v[82:83], v[84:85] op_sel:[1,0,0] neg_lo:[1,0,0] neg_hi:[1,0,0]
    v_pk_fma_f32 v[8:9], v[112:113], v[80:81], v[86:87] op_sel:[1,0,0]
    v_fma_f32 v84, v114, v6, v7
    v_fma_f32 v85, v114, v8, v9
    v_fma_f32 v80, -v115, v8, v84
    v_fma_f32 v81, v115, v6, v85
    ds_write_b64 v10, v[80:81]
    s_waitcnt vmcnt(0)
    s_waitcnt lgkmcnt(0)
    s_mov_b64 exec, 1
    ds_add_u32 v0, v124 offset:0
    s_mov_b64 exec, -1
    s_lshl_b32 s68, s76, 4
    s_sub_u32 s68, s4, s68
    s_sub_u32 s68, s68, 1
    s_lshl_b32 s68, s68, 13
    v_lshlrev_b32 v5, 16, v3
    v_sub_u32 v5, s68, v5
    v_lshl_add_u32 v5, v126, 3, v5
    s_lshl_b32 s69, s7, 7
    s_add_u32 s69, s69, 262144
    v_min_u32 v96, s69, v5
    v_add_u32 v5, 4294959104, v5
    v_min_u32 v97, s69, v5
    v_add_u32 v5, 4294959104, v5
    v_min_u32 v98, s69, v5
    v_add_u32 v5, 4294959104, v5
    v_min_u32 v99, s69, v5
    v_add_u32 v5, 4294959104, v5
    v_min_u32 v100, s69, v5
    v_add_u32 v5, 4294959104, v5
    v_min_u32 v101, s69, v5
    v_add_u32 v5, 4294959104, v5
    v_min_u32 v102, s69, v5
    v_add_u32 v5, 4294959104, v5
    v_min_u32 v103, s69, v5
    s_mov_b32 s75, 0
    L_sy_46:
    ds_read_b32 v125, v0 offset:0
    s_add_u32 s75, s75, 1
    s_waitcnt lgkmcnt(0)
    v_readfirstlane_b32 s68, v125
    s_cmp_ge_u32 s68, 26
    s_cbranch_scc1 L_syd_47
    s_cmp_lt_u32 s75, 200000
    s_cbranch_scc1 L_sy_46
    L_syd_47:
    ds_read_b64 v[80:81], v11 offset:0
    ds_read_b64 v[82:83], v11 offset:512
    ds_read_b64 v[84:85], v11 offset:1024
    ds_read_b64 v[86:87], v11 offset:1536
    s_waitcnt lgkmcnt(0)
    v_fma_f32 v88, v116, v80, v82
    v_fma_f32 v89, v116, v81, v83
    v_fma_f32 v104, -v117, v81, v88
    v_fma_f32 v105, v117, v80, v89
    v_fma_f32 v88, v116, v104, v84
    v_fma_f32 v89, v116, v105, v85
    v_fma_f32 v106, -v117, v105, v88
    v_fma_f32 v107, v117, v104, v89
    v_cmp_eq_u32 vcc, 1, v3
    s_cmp_lg_u32 s76, 0
    s_cbranch_scc1 L_tw1_48
    v_fma_f32 v88, v116, v106, v86
    v_fma_f32 v89, v116, v107, v87
    v_fma_f32 v108, -v117, v107, v88
    v_fma_f32 v110, v117, v106, v89
    v_mov_b32 v109, s6
    v_mov_b32 v111, s6
    v_lshlrev_b32 v7, 3, v126
    s_lshl_b32 s68, s4, 13
    s_mov_b32 exec_hi, 0
    buffer_store_dwordx4 v[108:111], v7, s[52:55], s68 offen sc1
    s_mov_b32 exec_hi, -1
    v_cndmask_b32 v12, 0, v80, vcc
    v_cndmask_b32 v13, 0, v81, vcc
    v_cndmask_b32 v14, 1.0, v116, vcc
    v_cndmask_b32 v15, 0, v117, vcc
    s_branch L_twd_49
L_tw1_48:
    v_cndmask_b32 v12, v104, v106, vcc
    v_cndmask_b32 v13, v105, v107, vcc
    v_mul_f32 v88, v117, v117
    v_mul_f32 v89, v116, v117
    v_fma_f32 v88, v116, v116, -v88
    v_add_f32 v89, v89, v89
    v_mul_f32 v90, v88, v116
    v_mul_f32 v91, v88, v117
    v_fma_f32 v90, -v89, v117, v90
    v_fma_f32 v91, v89, v116, v91
    v_cndmask_b32 v14, v88, v90, vcc
    v_cndmask_b32 v15, v89, v91, vcc
L_twd_49:
    s_mov_b32 s75, 0
    s_lshl_b32 s68, s81, 12
    s_add_u32 s68, s68, 133120
    v_lshlrev_b32 v9, 6, v2
    v_lshl_add_u32 v9, v3, 5, v9
    v_add_u32 v9, s68, v9
    v_bfe_u32 v108, v1, 2, 2
    v_lshl_add_u32 v108, v3, 3, v108
    v_lshlrev_b32 v108, 6, v108
    v_bfe_u32 v109, v1, 4, 1
    v_lshl_add_u32 v108, v109, 5, v108
    v_and_b32 v109, 3, v1
    v_lshl_add_u32 v108, v109, 3, v108
    v_add_u32 v108, s68, v108
    v_bfe_u32 v5, v1, 2, 2
    v_lshl_add_u32 v5, v3, 2, v5
    v_bfe_u32 v7, v1, 4, 1
    v_and_b32 v110, 3, v1
    v_lshlrev_b32 v110, 3, v110
    v_lshl_add_u32 v110, v7, 5, v110
    v_bfe_u32 v7, v1, 3, 1
    v_lshl_add_u32 v110, v7, 6, v110
    v_lshl_add_u32 v110, v5, 7, v110
    s_lshl_b32 s68, s77, 13
    s_add_u32 s68, s68, 66560
    s_lshl_b32 s69, s77, 6
    v_xor_b32 v110, s69, v110
    v_xor_b32 v111, 64, v110
    v_add_u32 v110, s68, v110
    v_add_u32 v111, s68, v111
    ds_read_b64_tr_b16 a[0:1], v110 offset:0
    ds_read_b64_tr_b16 a[2:3], v110 offset:1024
    ds_read_b64_tr_b16 a[4:5], v111 offset:0
    ds_read_b64_tr_b16 a[6:7], v111 offset:1024
    ds_read_b64_tr_b16 a[8:9], v110 offset:2048
    ds_read_b64_tr_b16 a[10:11], v110 offset:3072
    ds_read_b64_tr_b16 a[12:13], v111 offset:2048
    ds_read_b64_tr_b16 a[14:15], v111 offset:3072
    ds_read_b64_tr_b16 a[16:17], v110 offset:4096
    ds_read_b64_tr_b16 a[18:19], v110 offset:5120
    ds_read_b64_tr_b16 a[20:21], v111 offset:4096
    ds_read_b64_tr_b16 a[22:23], v111 offset:5120
    s_waitcnt lgkmcnt(3)
    ds_read_b64_tr_b16 a[24:25], v110 offset:6144
    ds_read_b64_tr_b16 a[26:27], v110 offset:7168
    ds_read_b64_tr_b16 a[28:29], v111 offset:6144
    ds_read_b64_tr_b16 a[30:31], v111 offset:7168
    ds_read_b64_tr_b16 a[32:33], v110 offset:16384
    ds_read_b64_tr_b16 a[34:35], v110 offset:17408
    ds_read_b64_tr_b16 a[36:37], v111 offset:16384
    ds_read_b64_tr_b16 a[38:39], v111 offset:17408
    ds_read_b64_tr_b16 a[40:41], v110 offset:18432
    ds_read_b64_tr_b16 a[42:43], v110 offset:19456
    ds_read_b64_tr_b16 a[44:45], v111 offset:18432
    ds_read_b64_tr_b16 a[46:47], v111 offset:19456
    s_waitcnt lgkmcnt(3)
    ds_read_b64_tr_b16 a[48:49], v110 offset:20480
    ds_read_b64_tr_b16 a[50:51], v110 offset:21504
    ds_read_b64_tr_b16 a[52:53], v111 offset:20480
    ds_read_b64_tr_b16 a[54:55], v111 offset:21504
    ds_read_b64_tr_b16 a[56:57], v110 offset:22528
    ds_read_b64_tr_b16 a[58:59], v110 offset:23552
    ds_read_b64_tr_b16 a[60:61], v111 offset:22528
    ds_read_b64_tr_b16 a[62:63], v111 offset:23552
    ds_read_b64_tr_b16 a[64:65], v110 offset:32768
    ds_read_b64_tr_b16 a[66:67], v110 offset:33792
    ds_read_b64_tr_b16 a[68:69], v111 offset:32768
    ds_read_b64_tr_b16 a[70:71], v111 offset:33792
    s_waitcnt lgkmcnt(3)
    ds_read_b64_tr_b16 a[72:73], v110 offset:34816
    ds_read_b64_tr_b16 a[74:75], v110 offset:35840
    ds_read_b64_tr_b16 a[76:77], v111 offset:34816
    ds_read_b64_tr_b16 a[78:79], v111 offset:35840
    ds_read_b64_tr_b16 a[80:81], v110 offset:36864
    ds_read_b64_tr_b16 a[82:83], v110 offset:37888
    ds_read_b64_tr_b16 a[84:85], v111 offset:36864
    ds_read_b64_tr_b16 a[86:87], v111 offset:37888
    ds_read_b64_tr_b16 a[88:89], v110 offset:38912
    ds_read_b64_tr_b16 a[90:91], v110 offset:39936
    ds_read_b64_tr_b16 a[92:93], v111 offset:38912
    ds_read_b64_tr_b16 a[94:95], v111 offset:39936
    s_waitcnt lgkmcnt(3)
    ds_read_b64_tr_b16 a[96:97], v110 offset:49152
    ds_read_b64_tr_b16 a[98:99], v110 offset:50176
    ds_read_b64_tr_b16 a[100:101], v111 offset:49152
    ds_read_b64_tr_b16 a[102:103], v111 offset:50176
    ds_read_b64_tr_b16 a[104:105], v110 offset:51200
    ds_read_b64_tr_b16 a[106:107], v110 offset:52224
    ds_read_b64_tr_b16 a[108:109], v111 offset:51200
    ds_read_b64_tr_b16 a[110:111], v111 offset:52224
    ds_read_b64_tr_b16 a[112:113], v110 offset:53248
    ds_read_b64_tr_b16 a[114:115], v110 offset:54272
    ds_read_b64_tr_b16 a[116:117], v111 offset:53248
    ds_read_b64_tr_b16 a[118:119], v111 offset:54272
    s_waitcnt lgkmcnt(3)
    ds_read_b64_tr_b16 a[120:121], v110 offset:55296
    ds_read_b64_tr_b16 a[122:123], v110 offset:56320
    ds_read_b64_tr_b16 a[124:125], v111 offset:55296
    ds_read_b64_tr_b16 a[126:127], v111 offset:56320
    s_setprio 0
    s_setprio 3
L_lb:
    buffer_load_dwordx4 v[64:67], v96, s[52:55], 0 offen sc1
    buffer_load_dwordx4 v[68:71], v97, s[52:55], 0 offen sc1
    buffer_load_dwordx4 v[72:75], v98, s[52:55], 0 offen sc1
    buffer_load_dwordx4 v[76:79], v99, s[52:55], 0 offen sc1
    buffer_load_dwordx4 v[80:83], v100, s[52:55], 0 offen sc1
    buffer_load_dwordx4 v[84:87], v101, s[52:55], 0 offen sc1
    buffer_load_dwordx4 v[88:91], v102, s[52:55], 0 offen sc1
    buffer_load_dwordx4 v[92:95], v103, s[52:55], 0 offen sc1
    s_add_u32 s75, s75, 1
    s_waitcnt vmcnt(0)
    v_min_u32 v5, v65, v67
    v_max3_u32 v7, s6, v65, v67
    v_min3_u32 v5, v5, v69, v71
    v_max3_u32 v7, v7, v69, v71
    v_min3_u32 v5, v5, v73, v75
    v_max3_u32 v7, v7, v73, v75
    v_min3_u32 v5, v5, v77, v79
    v_max3_u32 v7, v7, v77, v79
    v_min3_u32 v5, v5, v81, v83
    v_max3_u32 v7, v7, v81, v83
    v_min3_u32 v5, v5, v85, v87
    v_max3_u32 v7, v7, v85, v87
    v_min3_u32 v5, v5, v89, v91
    v_max3_u32 v7, v7, v89, v91
    v_min3_u32 v5, v5, v93, v95
    v_max3_u32 v7, v7, v93, v95
    v_min_u32 v5, s6, v5
    v_cmp_ne_u32 vcc, v5, v7
    s_cbranch_vccz L_lbd
    s_sleep 8
    s_cmp_lt_u32 s75, 200000
    s_cbranch_scc1 L_lb
L_lbd:
    v_fma_f32 v100, v118, v92, v88
    v_fma_f32 v101, v118, v94, v90
    v_fma_f32 v96, -v119, v94, v100
    v_fma_f32 v97, v119, v92, v101
    v_fma_f32 v100, v118, v96, v84
    v_fma_f32 v101, v118, v97, v86
    v_fma_f32 v98, -v119, v97, v100
    v_fma_f32 v99, v119, v96, v101
    v_fma_f32 v100, v118, v98, v80
    v_fma_f32 v101, v118, v99, v82
    v_fma_f32 v96, -v119, v99, v100
    v_fma_f32 v97, v119, v98, v101
    v_fma_f32 v100, v118, v96, v76
    v_fma_f32 v101, v118, v97, v78
    v_fma_f32 v98, -v119, v97, v100
    v_fma_f32 v99, v119, v96, v101
    v_fma_f32 v100, v118, v98, v72
    v_fma_f32 v101, v118, v99, v74
    v_fma_f32 v96, -v119, v99, v100
    v_fma_f32 v97, v119, v98, v101
    v_fma_f32 v100, v118, v96, v68
    v_fma_f32 v101, v118, v97, v70
    v_fma_f32 v98, -v119, v97, v100
    v_fma_f32 v99, v119, v96, v101
    v_fma_f32 v100, v118, v98, v64
    v_fma_f32 v101, v118, v99, v66
    v_fma_f32 v96, -v119, v99, v100
    v_fma_f32 v97, v119, v98, v101
    ds_write_b64 v10, v[96:97] offset:2048
    s_waitcnt lgkmcnt(0)
    s_mov_b64 exec, 1
    ds_add_u32 v0, v124 offset:0
    s_mov_b64 exec, -1
    s_mov_b32 s75, 0
    L_sy_50:
    ds_read_b32 v125, v0 offset:0
    s_add_u32 s75, s75, 1
    s_waitcnt lgkmcnt(0)
    v_readfirstlane_b32 s68, v125
    s_cmp_ge_u32 s68, 30
    s_cbranch_scc1 L_syd_51
    s_cmp_lt_u32 s75, 200000
    s_cbranch_scc1 L_sy_50
    L_syd_51:
    ds_read_b64 v[80:81], v11 offset:2048
    ds_read_b64 v[82:83], v11 offset:2560
    ds_read_b64 v[84:85], v11 offset:3072
    ds_read_b64 v[86:87], v11 offset:3584
    s_waitcnt lgkmcnt(0)
    v_fma_f32 v100, v120, v86, v84
    v_fma_f32 v101, v120, v87, v85
    v_fma_f32 v96, -v121, v87, v100
    v_fma_f32 v97, v121, v86, v101
    v_fma_f32 v100, v120, v96, v82
    v_fma_f32 v101, v120, v97, v83
    v_fma_f32 v98, -v121, v97, v100
    v_fma_f32 v99, v121, v96, v101
    v_fma_f32 v100, v120, v98, v80
    v_fma_f32 v101, v120, v99, v81
    v_fma_f32 v96, -v121, v99, v100
    v_fma_f32 v97, v121, v98, v101
    v_fma_f32 v100, v14, v96, v12
    v_fma_f32 v101, v14, v97, v13
    v_fma_f32 v104, -v15, v97, v100
    v_fma_f32 v106, v15, v96, v101
    v_fma_f32 v100, v114, v104, v6
    v_fma_f32 v101, v114, v106, v8
    v_fma_f32 v105, -v115, v106, v100
    v_fma_f32 v107, v115, v104, v101
    v_pk_fma_f32 v[100:101], v[112:113], v[104:105], v[16:17] op_sel_hi:[0,1,1]
    v_pk_fma_f32 v[102:103], v[112:113], v[106:107], v[32:33] op_sel_hi:[0,1,1]
    v_pk_fma_f32 v[16:17], v[112:113], v[106:107], v[100:101] op_sel:[1,0,0] neg_lo:[1,0,0] neg_hi:[1,0,0]
    v_pk_fma_f32 v[32:33], v[112:113], v[104:105], v[102:103] op_sel:[1,0,0]
    v_pk_mul_f32 v[96:97], v[122:123], v[32:33] op_sel:[1,0]
    v_pk_mul_f32 v[98:99], v[122:123], v[16:17] op_sel:[1,0]
    v_pk_fma_f32 v[96:97], v[122:123], v[16:17], v[96:97] op_sel_hi:[0,1,1] neg_lo:[0,0,1] neg_hi:[0,0,1]
    v_pk_fma_f32 v[98:99], v[122:123], v[32:33], v[98:99] op_sel_hi:[0,1,1] neg_lo:[1,0,1] neg_hi:[1,0,1]
    v_cvt_pk_bf16_f32 v80, v96, v97
    v_cvt_pk_bf16_f32 v88, v98, v99
    v_pk_fma_f32 v[100:101], v[112:113], v[16:17], v[18:19] op_sel_hi:[0,1,1]
    v_pk_fma_f32 v[102:103], v[112:113], v[32:33], v[34:35] op_sel_hi:[0,1,1]
    v_pk_fma_f32 v[18:19], v[112:113], v[32:33], v[100:101] op_sel:[1,0,0] neg_lo:[1,0,0] neg_hi:[1,0,0]
    v_pk_fma_f32 v[34:35], v[112:113], v[16:17], v[102:103] op_sel:[1,0,0]
    v_pk_mul_f32 v[96:97], v[122:123], v[34:35] op_sel:[1,0]
    v_pk_mul_f32 v[98:99], v[122:123], v[18:19] op_sel:[1,0]
    v_pk_fma_f32 v[96:97], v[122:123], v[18:19], v[96:97] op_sel_hi:[0,1,1] neg_lo:[0,0,1] neg_hi:[0,0,1]
    v_pk_fma_f32 v[98:99], v[122:123], v[34:35], v[98:99] op_sel_hi:[0,1,1] neg_lo:[1,0,1] neg_hi:[1,0,1]
    v_cvt_pk_bf16_f32 v81, v96, v97
    v_cvt_pk_bf16_f32 v89, v98, v99
    v_pk_fma_f32 v[100:101], v[112:113], v[18:19], v[20:21] op_sel_hi:[0,1,1]
    v_pk_fma_f32 v[102:103], v[112:113], v[34:35], v[36:37] op_sel_hi:[0,1,1]
    v_pk_fma_f32 v[20:21], v[112:113], v[34:35], v[100:101] op_sel:[1,0,0] neg_lo:[1,0,0] neg_hi:[1,0,0]
    v_pk_fma_f32 v[36:37], v[112:113], v[18:19], v[102:103] op_sel:[1,0,0]
    v_pk_mul_f32 v[96:97], v[122:123], v[36:37] op_sel:[1,0]
    v_pk_mul_f32 v[98:99], v[122:123], v[20:21] op_sel:[1,0]
    v_pk_fma_f32 v[96:97], v[122:123], v[20:21], v[96:97] op_sel_hi:[0,1,1] neg_lo:[0,0,1] neg_hi:[0,0,1]
    v_pk_fma_f32 v[98:99], v[122:123], v[36:37], v[98:99] op_sel_hi:[0,1,1] neg_lo:[1,0,1] neg_hi:[1,0,1]
    v_cvt_pk_bf16_f32 v82, v96, v97
    v_cvt_pk_bf16_f32 v90, v98, v99
    v_pk_fma_f32 v[100:101], v[112:113], v[20:21], v[22:23] op_sel_hi:[0,1,1]
    v_pk_fma_f32 v[102:103], v[112:113], v[36:37], v[38:39] op_sel_hi:[0,1,1]
    v_pk_fma_f32 v[22:23], v[112:113], v[36:37], v[100:101] op_sel:[1,0,0] neg_lo:[1,0,0] neg_hi:[1,0,0]
    v_pk_fma_f32 v[38:39], v[112:113], v[20:21], v[102:103] op_sel:[1,0,0]
    v_pk_mul_f32 v[96:97], v[122:123], v[38:39] op_sel:[1,0]
    v_pk_mul_f32 v[98:99], v[122:123], v[22:23] op_sel:[1,0]
    v_pk_fma_f32 v[96:97], v[122:123], v[22:23], v[96:97] op_sel_hi:[0,1,1] neg_lo:[0,0,1] neg_hi:[0,0,1]
    v_pk_fma_f32 v[98:99], v[122:123], v[38:39], v[98:99] op_sel_hi:[0,1,1] neg_lo:[1,0,1] neg_hi:[1,0,1]
    v_cvt_pk_bf16_f32 v83, v96, v97
    v_cvt_pk_bf16_f32 v91, v98, v99
    ds_write_b128 v9, v[80:83]
    ds_write_b128 v9, v[88:91] offset:2048
    v_pk_fma_f32 v[100:101], v[112:113], v[22:23], v[24:25] op_sel_hi:[0,1,1]
    v_pk_fma_f32 v[102:103], v[112:113], v[38:39], v[40:41] op_sel_hi:[0,1,1]
    v_pk_fma_f32 v[24:25], v[112:113], v[38:39], v[100:101] op_sel:[1,0,0] neg_lo:[1,0,0] neg_hi:[1,0,0]
    v_pk_fma_f32 v[40:41], v[112:113], v[22:23], v[102:103] op_sel:[1,0,0]
    v_pk_mul_f32 v[96:97], v[122:123], v[40:41] op_sel:[1,0]
    v_pk_mul_f32 v[98:99], v[122:123], v[24:25] op_sel:[1,0]
    v_pk_fma_f32 v[96:97], v[122:123], v[24:25], v[96:97] op_sel_hi:[0,1,1] neg_lo:[0,0,1] neg_hi:[0,0,1]
    v_pk_fma_f32 v[98:99], v[122:123], v[40:41], v[98:99] op_sel_hi:[0,1,1] neg_lo:[1,0,1] neg_hi:[1,0,1]
    v_cvt_pk_bf16_f32 v84, v96, v97
    v_cvt_pk_bf16_f32 v92, v98, v99
    v_pk_fma_f32 v[100:101], v[112:113], v[24:25], v[26:27] op_sel_hi:[0,1,1]
    v_pk_fma_f32 v[102:103], v[112:113], v[40:41], v[42:43] op_sel_hi:[0,1,1]
    v_pk_fma_f32 v[26:27], v[112:113], v[40:41], v[100:101] op_sel:[1,0,0] neg_lo:[1,0,0] neg_hi:[1,0,0]
    v_pk_fma_f32 v[42:43], v[112:113], v[24:25], v[102:103] op_sel:[1,0,0]
    v_pk_mul_f32 v[96:97], v[122:123], v[42:43] op_sel:[1,0]
    v_pk_mul_f32 v[98:99], v[122:123], v[26:27] op_sel:[1,0]
    v_pk_fma_f32 v[96:97], v[122:123], v[26:27], v[96:97] op_sel_hi:[0,1,1] neg_lo:[0,0,1] neg_hi:[0,0,1]
    v_pk_fma_f32 v[98:99], v[122:123], v[42:43], v[98:99] op_sel_hi:[0,1,1] neg_lo:[1,0,1] neg_hi:[1,0,1]
    v_cvt_pk_bf16_f32 v85, v96, v97
    v_cvt_pk_bf16_f32 v93, v98, v99
    v_pk_fma_f32 v[100:101], v[112:113], v[26:27], v[28:29] op_sel_hi:[0,1,1]
    v_pk_fma_f32 v[102:103], v[112:113], v[42:43], v[44:45] op_sel_hi:[0,1,1]
    v_pk_fma_f32 v[28:29], v[112:113], v[42:43], v[100:101] op_sel:[1,0,0] neg_lo:[1,0,0] neg_hi:[1,0,0]
    v_pk_fma_f32 v[44:45], v[112:113], v[26:27], v[102:103] op_sel:[1,0,0]
    v_pk_mul_f32 v[96:97], v[122:123], v[44:45] op_sel:[1,0]
    v_pk_mul_f32 v[98:99], v[122:123], v[28:29] op_sel:[1,0]
    v_pk_fma_f32 v[96:97], v[122:123], v[28:29], v[96:97] op_sel_hi:[0,1,1] neg_lo:[0,0,1] neg_hi:[0,0,1]
    v_pk_fma_f32 v[98:99], v[122:123], v[44:45], v[98:99] op_sel_hi:[0,1,1] neg_lo:[1,0,1] neg_hi:[1,0,1]
    v_cvt_pk_bf16_f32 v86, v96, v97
    v_cvt_pk_bf16_f32 v94, v98, v99
    v_pk_fma_f32 v[100:101], v[112:113], v[28:29], v[30:31] op_sel_hi:[0,1,1]
    v_pk_fma_f32 v[102:103], v[112:113], v[44:45], v[46:47] op_sel_hi:[0,1,1]
    v_pk_fma_f32 v[30:31], v[112:113], v[44:45], v[100:101] op_sel:[1,0,0] neg_lo:[1,0,0] neg_hi:[1,0,0]
    v_pk_fma_f32 v[46:47], v[112:113], v[28:29], v[102:103] op_sel:[1,0,0]
    v_pk_mul_f32 v[96:97], v[122:123], v[46:47] op_sel:[1,0]
    v_pk_mul_f32 v[98:99], v[122:123], v[30:31] op_sel:[1,0]
    v_pk_fma_f32 v[96:97], v[122:123], v[30:31], v[96:97] op_sel_hi:[0,1,1] neg_lo:[0,0,1] neg_hi:[0,0,1]
    v_pk_fma_f32 v[98:99], v[122:123], v[46:47], v[98:99] op_sel_hi:[0,1,1] neg_lo:[1,0,1] neg_hi:[1,0,1]
    v_cvt_pk_bf16_f32 v87, v96, v97
    v_cvt_pk_bf16_f32 v95, v98, v99
    ds_write_b128 v9, v[84:87] offset:16
    ds_write_b128 v9, v[92:95] offset:2064
    s_lshl_b32 s79, s4, 1
    s_add_u32 s79, s79, s76
    s_lshl_b32 s79, s79, 16
    s_add_u32 s79, s79, 4194304
    s_lshl_b32 s69, s5, 12
    s_lshl_b32 s83, s77, 11
    s_add_u32 s69, s69, s83
    s_add_u32 s68, s79, s69
    s_add_u32 s69, s68, 32768
    s_waitcnt lgkmcnt(0)
    ds_read_b64_tr_b16 v[64:65], v108 offset:0
    ds_read_b64_tr_b16 v[66:67], v108 offset:256
    ds_read_b64_tr_b16 v[68:69], v108 offset:1024
    ds_read_b64_tr_b16 v[70:71], v108 offset:1280
    ds_read_b64_tr_b16 v[72:73], v108 offset:2048
    ds_read_b64_tr_b16 v[74:75], v108 offset:2304
    ds_read_b64_tr_b16 v[76:77], v108 offset:3072
    ds_read_b64_tr_b16 v[78:79], v108 offset:3328
    s_waitcnt lgkmcnt(6)
    buffer_store_dwordx4 v[64:67], v4, s[48:51], s68 offen offset:0 sc1
    s_waitcnt lgkmcnt(4)
    buffer_store_dwordx4 v[68:71], v4, s[48:51], s68 offen offset:1024 sc1
    s_waitcnt lgkmcnt(2)
    buffer_store_dwordx4 v[72:75], v4, s[48:51], s69 offen offset:0 sc1
    s_waitcnt lgkmcnt(0)
    buffer_store_dwordx4 v[76:79], v4, s[48:51], s69 offen offset:1024 sc1
    s_lshl_b32 s83, s4, 12
    s_add_u32 s83, s83, 36864
    v_and_b32 v5, 15, v1
    v_lshlrev_b32 v5, 8, v5
    s_lshl_b32 s68, s76, 7
    s_add_u32 s68, s68, s83
    v_add_u32 v5, s68, v5
    v_mov_b32 v12, s6
    v_mov_b32 v13, 0
    s_lshl_b32 s69, s5, 2
    s_add_u32 s69, s69, s81
    s_lshl_b32 s69, s69, 7
    s_add_u32 s69, s69, s83
    s_waitcnt vmcnt(0)
    s_mov_b64 exec, 1
    buffer_store_dword v12, v13, s[48:51], s69 offen sc1
    ds_add_u32 v0, v124 offset:28
    s_mov_b64 exec, -1
    v_bfe_u32 v6, v1, 4, 1
    v_and_b32 v7, 15, v1
    v_lshlrev_b32 v7, 4, v7
    v_lshl_add_u32 v7, v6, 9, v7
    v_lshl_add_u32 v7, v3, 15, v7
    s_lshr_b32 s73, s70, 1
    s_lshr_b32 s74, s71, 1
    s_setprio 0
    s_add_u32 m0, s73, 99840
    s_add_u32 s72, s74, 0
    buffer_load_dwordx4 v7, s[32:35], s72 offen offset:0 lds
    s_waitcnt vmcnt(6)
    s_add_u32 m0, s73, 99856
    s_nop 0
    buffer_load_dwordx4 v7, s[32:35], s72 offen offset:1024 lds
    s_waitcnt vmcnt(6)
    s_add_u32 m0, s73, 99872
    s_nop 0
    buffer_load_dwordx4 v7, s[32:35], s72 offen offset:2048 lds
    s_waitcnt vmcnt(6)
    s_add_u32 m0, s73, 99888
    s_nop 0
    buffer_load_dwordx4 v7, s[32:35], s72 offen offset:3072 lds
    s_waitcnt vmcnt(6)
    s_add_u32 m0, s73, 104000
    s_add_u32 s72, s74, 4096
    buffer_load_dwordx4 v7, s[32:35], s72 offen offset:0 lds
    s_waitcnt vmcnt(6)
    s_add_u32 m0, s73, 104016
    s_nop 0
    buffer_load_dwordx4 v7, s[32:35], s72 offen offset:1024 lds
    s_waitcnt vmcnt(6)
    s_add_u32 m0, s73, 104032
    s_nop 0
    buffer_load_dwordx4 v7, s[32:35], s72 offen offset:2048 lds
    s_waitcnt vmcnt(6)
    s_add_u32 m0, s73, 104048
    s_nop 0
    buffer_load_dwordx4 v7, s[32:35], s72 offen offset:3072 lds
    s_waitcnt vmcnt(6)
    s_add_u32 m0, s73, 66560
    s_add_u32 s72, s74, 256
    buffer_load_dwordx4 v7, s[32:35], s72 offen offset:0 lds
    s_waitcnt vmcnt(6)
    s_add_u32 m0, s73, 66576
    s_nop 0
    buffer_load_dwordx4 v7, s[32:35], s72 offen offset:1024 lds
    s_waitcnt vmcnt(6)
    s_add_u32 m0, s73, 66592
    s_nop 0
    buffer_load_dwordx4 v7, s[32:35], s72 offen offset:2048 lds
    s_waitcnt vmcnt(6)
    s_add_u32 m0, s73, 66608
    s_nop 0
    buffer_load_dwordx4 v7, s[32:35], s72 offen offset:3072 lds
    s_waitcnt vmcnt(6)
    s_add_u32 m0, s73, 70720
    s_add_u32 s72, s74, 4352
    buffer_load_dwordx4 v7, s[32:35], s72 offen offset:0 lds
    s_waitcnt vmcnt(6)
    s_add_u32 m0, s73, 70736
    s_nop 0
    buffer_load_dwordx4 v7, s[32:35], s72 offen offset:1024 lds
    s_waitcnt vmcnt(6)
    s_add_u32 m0, s73, 70752
    s_nop 0
    buffer_load_dwordx4 v7, s[32:35], s72 offen offset:2048 lds
    s_waitcnt vmcnt(6)
    s_add_u32 m0, s73, 70768
    s_nop 0
    buffer_load_dwordx4 v7, s[32:35], s72 offen offset:3072 lds
    s_waitcnt vmcnt(6)
    s_setprio 3
    v_mul_u32_u24 v10, 1040, v2
    v_lshl_add_u32 v10, v3, 4, v10
    s_mul_i32 s68, s77, 33792
    s_mul_i32 s69, s77, 4294934528
    s_add_u32 s69, s69, 33280
    s_mul_i32 s73, s77, 768
    s_mul_i32 s74, s77, 4294967040
    s_add_u32 s73, s73, 66560
    s_add_u32 s74, s74, 67072
    v_add_u32 v14, s73, v10
    v_add_u32 v15, s74, v10
    v_add_u32 v11, s69, v10
    v_add_u32 v10, s68, v10
    s_lshl_b32 s69, s77, 14
    s_add_u32 s79, s79, s69
    s_lshl_b32 s69, s77, 12
    s_add_u32 s82, s82, s69
    s_xor_b32 s68, s81, 2
    s_lshl_b32 s68, s68, 12
    v_add_u32 v114, s68, v4
    s_lshl_b32 s68, s81, 12
    v_add_u32 v115, s68, v4
    v_add_u32 v119, 105472, v114
    v_add_u32 v120, 105472, v115
    s_lshl_b32 s68, s76, 17
    s_lshl_b32 s69, s5, 8
    s_add_u32 s68, s68, s69
    s_lshl_b32 s69, s77, 7
    s_add_u32 s68, s68, s69
    v_lshlrev_b32 v113, 2, v2
    v_add_u32 v113, s68, v113
    v_lshl_add_u32 v118, v3, 14, v113
    v_add_u32 v118, 2048, v118
    v_lshl_add_u32 v113, v3, 13, v113
    s_mov_b32 s75, 0
L_pl_52:
    buffer_load_dword v12, v5, s[48:51], 0 offen sc1
    s_add_u32 s75, s75, 1
    s_waitcnt vmcnt(0)
    v_cmp_ne_u32 vcc, s6, v12
    s_cbranch_vccz L_pld_53
    s_sleep 2
    s_cmp_lt_u32 s75, 200000
    s_cbranch_scc1 L_pl_52
    L_pld_53:
    s_mov_b64 exec, 1
    ds_add_u32 v0, v124 offset:0
    s_mov_b64 exec, -1
    buffer_load_dwordx4 v[16:19], v4, s[48:51], s79 offen offset:0 sc1
    buffer_load_dwordx4 v[20:23], v4, s[48:51], s79 offen offset:1024 sc1
    buffer_load_dwordx4 v[24:27], v4, s[48:51], s79 offen offset:2048 sc1
    buffer_load_dwordx4 v[28:31], v4, s[48:51], s79 offen offset:3072 sc1
    s_add_u32 s79, s79, 4096
    buffer_load_dwordx4 v[32:35], v4, s[48:51], s79 offen offset:0 sc1
    buffer_load_dwordx4 v[36:39], v4, s[48:51], s79 offen offset:1024 sc1
    buffer_load_dwordx4 v[40:43], v4, s[48:51], s79 offen offset:2048 sc1
    s_mov_b32 s75, 0
    L_sy_54:
    ds_read_b32 v125, v0 offset:0
    s_add_u32 s75, s75, 1
    s_waitcnt lgkmcnt(0)
    v_readfirstlane_b32 s68, v125
    s_cmp_ge_u32 s68, 34
    s_cbranch_scc1 L_syd_55
    s_cmp_lt_u32 s75, 200000
    s_cbranch_scc1 L_sy_54
    L_syd_55:
    s_setprio 0
    ds_read_b128 v[80:83], v14 offset:33280
    ds_read_b128 v[84:87], v15 offset:33280
    ds_read_b128 v[88:91], v14 offset:33312
    ds_read_b128 v[92:95], v15 offset:33312
    buffer_load_dwordx4 v[44:47], v4, s[48:51], s79 offen offset:3072 sc1
    s_add_u32 m0, s70, 0
    s_add_u32 s72, s71, 0
    buffer_load_dwordx4 v4, s[36:39], s72 offen offset:0 lds
    s_waitcnt vmcnt(6)
    s_add_u32 m0, s70, 16
    s_nop 0
    buffer_load_dwordx4 v4, s[36:39], s72 offen offset:1024 lds
    s_waitcnt vmcnt(6)
    ds_read_b128 v[96:99], v14 offset:33344
    ds_read_b128 v[100:103], v15 offset:33344
    s_waitcnt vmcnt(9) lgkmcnt(4)
    v_mfma_f32_32x32x16_bf16 v[64:79], v[16:19], v[84:87], 0
    v_mfma_f32_32x32x16_bf16 v[48:63], v[16:19], v[80:83], v[48:63]
    s_add_u32 s79, s79, 4096
    buffer_load_dwordx4 v[16:19], v4, s[48:51], s79 offen offset:0 sc1
    s_add_u32 m0, s70, 32
    s_nop 0
    buffer_load_dwordx4 v4, s[36:39], s72 offen offset:2048 lds
    s_waitcnt vmcnt(6)
    s_add_u32 m0, s70, 48
    s_nop 0
    buffer_load_dwordx4 v4, s[36:39], s72 offen offset:3072 lds
    s_waitcnt vmcnt(6)
    ds_read_b128 v[80:83], v14 offset:33376
    ds_read_b128 v[84:87], v15 offset:33376
    s_waitcnt vmcnt(11) lgkmcnt(4)
    v_mfma_f32_32x32x16_bf16 v[64:79], v[20:23], v[92:95], v[64:79]
    v_mfma_f32_32x32x16_bf16 v[48:63], v[20:23], v[88:91], v[48:63]
    buffer_load_dwordx4 v[20:23], v4, s[48:51], s79 offen offset:1024 sc1
    s_add_u32 m0, s70, 4160
    s_add_u32 s72, s71, 4096
    buffer_load_dwordx4 v4, s[36:39], s72 offen offset:0 lds
    s_waitcnt vmcnt(6)
    s_add_u32 m0, s70, 4176
    s_nop 0
    buffer_load_dwordx4 v4, s[36:39], s72 offen offset:1024 lds
    s_waitcnt vmcnt(6)
    ds_read_b128 v[88:91], v14 offset:33408
    ds_read_b128 v[92:95], v15 offset:33408
    s_waitcnt vmcnt(13) lgkmcnt(4)
    v_mfma_f32_32x32x16_bf16 v[64:79], v[24:27], v[100:103], v[64:79]
    v_mfma_f32_32x32x16_bf16 v[48:63], v[24:27], v[96:99], v[48:63]
    buffer_load_dwordx4 v[24:27], v4, s[48:51], s79 offen offset:2048 sc1
    s_add_u32 m0, s70, 4192
    s_nop 0
    buffer_load_dwordx4 v4, s[36:39], s72 offen offset:2048 lds
    s_waitcnt vmcnt(6)
    s_add_u32 m0, s70, 4208
    s_nop 0
    buffer_load_dwordx4 v4, s[36:39], s72 offen offset:3072 lds
    s_waitcnt vmcnt(6)
    ds_read_b128 v[96:99], v14 offset:33440
    ds_read_b128 v[100:103], v15 offset:33440
    s_waitcnt vmcnt(15) lgkmcnt(4)
    v_mfma_f32_32x32x16_bf16 v[64:79], v[28:31], v[84:87], v[64:79]
    v_mfma_f32_32x32x16_bf16 v[48:63], v[28:31], v[80:83], v[48:63]
    buffer_load_dwordx4 v[28:31], v4, s[48:51], s79 offen offset:3072 sc1
    s_add_u32 m0, s70, 8320
    s_add_u32 s72, s71, 8192
    buffer_load_dwordx4 v4, s[36:39], s72 offen offset:0 lds
    s_waitcnt vmcnt(6)
    s_add_u32 m0, s70, 8336
    s_nop 0
    buffer_load_dwordx4 v4, s[36:39], s72 offen offset:1024 lds
    s_waitcnt vmcnt(6)
    ds_read_b128 v[80:83], v14 offset:33472
    ds_read_b128 v[84:87], v15 offset:33472
    s_waitcnt vmcnt(17) lgkmcnt(4)
    v_mfma_f32_32x32x16_bf16 v[64:79], v[32:35], v[92:95], v[64:79]
    v_mfma_f32_32x32x16_bf16 v[48:63], v[32:35], v[88:91], v[48:63]
    s_add_u32 s79, s79, 4096
    buffer_load_dwordx4 v[32:35], v4, s[48:51], s79 offen offset:0 sc1
    s_add_u32 m0, s70, 8352
    s_nop 0
    buffer_load_dwordx4 v4, s[36:39], s72 offen offset:2048 lds
    s_waitcnt vmcnt(6)
    s_add_u32 m0, s70, 8368
    s_nop 0
    buffer_load_dwordx4 v4, s[36:39], s72 offen offset:3072 lds
    s_waitcnt vmcnt(6)
    ds_read_b128 v[88:91], v14 offset:33504
    ds_read_b128 v[92:95], v15 offset:33504
    s_waitcnt vmcnt(19) lgkmcnt(4)
    v_mfma_f32_32x32x16_bf16 v[64:79], v[36:39], v[100:103], v[64:79]
    v_mfma_f32_32x32x16_bf16 v[48:63], v[36:39], v[96:99], v[48:63]
    buffer_load_dwordx4 v[36:39], v4, s[48:51], s79 offen offset:1024 sc1
    s_add_u32 m0, s70, 12480
    s_add_u32 s72, s71, 12288
    buffer_load_dwordx4 v4, s[36:39], s72 offen offset:0 lds
    s_waitcnt vmcnt(6)
    s_add_u32 m0, s70, 12496
    s_nop 0
    buffer_load_dwordx4 v4, s[36:39], s72 offen offset:1024 lds
    s_waitcnt vmcnt(6)
    ds_read_b128 v[96:99], v14 offset:0
    ds_read_b128 v[100:103], v15 offset:0
    s_waitcnt vmcnt(21) lgkmcnt(4)
    v_mfma_f32_32x32x16_bf16 v[64:79], v[40:43], v[84:87], v[64:79]
    v_mfma_f32_32x32x16_bf16 v[48:63], v[40:43], v[80:83], v[48:63]
    buffer_load_dwordx4 v[40:43], v4, s[48:51], s79 offen offset:2048 sc1
    s_add_u32 m0, s70, 12512
    s_nop 0
    buffer_load_dwordx4 v4, s[36:39], s72 offen offset:2048 lds
    s_waitcnt vmcnt(6)
    s_add_u32 m0, s70, 12528
    s_nop 0
    buffer_load_dwordx4 v4, s[36:39], s72 offen offset:3072 lds
    s_waitcnt vmcnt(6)
    ds_read_b128 v[80:83], v14 offset:32
    ds_read_b128 v[84:87], v15 offset:32
    s_waitcnt vmcnt(23) lgkmcnt(4)
    s_mov_b64 exec, 1
    ds_add_u32 v0, v124 offset:8
    s_mov_b64 exec, -1
    v_mfma_f32_32x32x16_bf16 v[64:79], v[44:47], v[92:95], v[64:79]
    v_mfma_f32_32x32x16_bf16 v[48:63], v[44:47], v[88:91], v[48:63]
    buffer_load_dwordx4 v[44:47], v4, s[48:51], s79 offen offset:3072 sc1
    ds_read_b128 v[88:91], v14 offset:64
    ds_read_b128 v[92:95], v15 offset:64
    s_waitcnt vmcnt(21) lgkmcnt(4)
    v_mfma_f32_32x32x16_bf16 v[64:79], v[16:19], v[100:103], v[64:79]
    v_mfma_f32_32x32x16_bf16 v[48:63], v[16:19], v[96:99], v[48:63]
    s_add_u32 s79, s79, 20480
    buffer_load_dwordx4 v[16:19], v4, s[48:51], s79 offen offset:0 sc1
    ds_read_b128 v[96:99], v14 offset:96
    ds_read_b128 v[100:103], v15 offset:96
    s_waitcnt vmcnt(19) lgkmcnt(4)
    v_mfma_f32_32x32x16_bf16 v[64:79], v[20:23], v[84:87], v[64:79]
    v_mfma_f32_32x32x16_bf16 v[48:63], v[20:23], v[80:83], v[48:63]
    buffer_load_dwordx4 v[20:23], v4, s[48:51], s79 offen offset:1024 sc1
    ds_read_b128 v[80:83], v14 offset:128
    ds_read_b128 v[84:87], v15 offset:128
    s_waitcnt vmcnt(17) lgkmcnt(4)
    v_mfma_f32_32x32x16_bf16 v[64:79], v[24:27], v[92:95], v[64:79]
    v_mfma_f32_32x32x16_bf16 v[48:63], v[24:27], v[88:91], v[48:63]
    buffer_load_dwordx4 v[24:27], v4, s[48:51], s79 offen offset:2048 sc1
    ds_read_b128 v[88:91], v14 offset:160
    ds_read_b128 v[92:95], v15 offset:160
    s_waitcnt vmcnt(15) lgkmcnt(4)
    v_mfma_f32_32x32x16_bf16 v[64:79], v[28:31], v[100:103], v[64:79]
    v_mfma_f32_32x32x16_bf16 v[48:63], v[28:31], v[96:99], v[48:63]
    s_setprio 3
    s_waitcnt vmcnt(0)
    s_mov_b64 exec, 1
    ds_add_u32 v0, v124 offset:0
    s_mov_b64 exec, -1
    s_mov_b32 s75, 0
    L_sy_56:
    ds_read_b32 v125, v0 offset:0
    s_add_u32 s75, s75, 1
    s_waitcnt lgkmcnt(0)
    v_readfirstlane_b32 s68, v125
    s_cmp_ge_u32 s68, 38
    s_cbranch_scc1 L_syd_57
    s_sleep 2
    s_cmp_lt_u32 s75, 200000
    s_cbranch_scc1 L_sy_56
    L_syd_57:
    s_mov_b32 s75, 0
    L_sy_58:
    ds_read_b32 v125, v0 offset:12
    s_add_u32 s75, s75, 1
    s_waitcnt lgkmcnt(0)
    v_readfirstlane_b32 s68, v125
    s_cmp_ge_u32 s68, 8
    s_cbranch_scc1 L_syd_59
    s_sleep 2
    s_cmp_lt_u32 s75, 200000
    s_cbranch_scc1 L_sy_58
    L_syd_59:
    s_setprio 0
    buffer_load_dwordx4 v[28:31], v4, s[48:51], s79 offen offset:3072 sc1
    ds_read_b128 v[96:99], v14 offset:192
    ds_read_b128 v[100:103], v15 offset:192
    s_waitcnt vmcnt(13) lgkmcnt(4)
    v_mfma_f32_32x32x16_bf16 v[64:79], v[32:35], v[84:87], v[64:79]
    v_mfma_f32_32x32x16_bf16 v[48:63], v[32:35], v[80:83], v[48:63]
    s_add_u32 s79, s79, 4096
    buffer_load_dwordx4 v[32:35], v4, s[48:51], s79 offen offset:0 sc1
    ds_read_b128 v[80:83], v14 offset:224
    ds_read_b128 v[84:87], v15 offset:224
    s_waitcnt vmcnt(11) lgkmcnt(4)
    v_mfma_f32_32x32x16_bf16 v[64:79], v[36:39], v[92:95], v[64:79]
    v_mfma_f32_32x32x16_bf16 v[48:63], v[36:39], v[88:91], v[48:63]
    buffer_load_dwordx4 v[36:39], v4, s[48:51], s79 offen offset:1024 sc1
    ds_read_b128 v[88:91], v10 offset:0
    ds_read_b128 v[92:95], v11 offset:0
    s_waitcnt vmcnt(9) lgkmcnt(4)
    v_mfma_f32_32x32x16_bf16 v[64:79], v[40:43], v[100:103], v[64:79]
    v_mfma_f32_32x32x16_bf16 v[48:63], v[40:43], v[96:99], v[48:63]
    buffer_load_dwordx4 v[40:43], v4, s[48:51], s79 offen offset:2048 sc1
    ds_read_b128 v[96:99], v10 offset:32
    ds_read_b128 v[100:103], v11 offset:32
    s_waitcnt vmcnt(7) lgkmcnt(4)
    v_mfma_f32_32x32x16_bf16 v[64:79], v[44:47], v[84:87], v[64:79]
    v_mfma_f32_32x32x16_bf16 v[48:63], v[44:47], v[80:83], v[48:63]
    buffer_load_dwordx4 v[44:47], v4, s[48:51], s79 offen offset:3072 sc1
    ds_read_b128 v[80:83], v10 offset:64
    ds_read_b128 v[84:87], v11 offset:64
    s_waitcnt vmcnt(7) lgkmcnt(4)
    v_mfma_f32_32x32x16_bf16 v[64:79], v[16:19], v[92:95], v[64:79]
    v_mfma_f32_32x32x16_bf16 v[48:63], v[16:19], v[88:91], v[48:63]
    s_add_u32 s79, s79, 4096
    buffer_load_dwordx4 v[16:19], v4, s[48:51], s79 offen offset:0 sc1
    ds_read_b128 v[88:91], v10 offset:96
    ds_read_b128 v[92:95], v11 offset:96
    s_waitcnt vmcnt(7) lgkmcnt(4)
    v_mfma_f32_32x32x16_bf16 v[64:79], v[20:23], v[100:103], v[64:79]
    v_mfma_f32_32x32x16_bf16 v[48:63], v[20:23], v[96:99], v[48:63]
    buffer_load_dwordx4 v[20:23], v4, s[48:51], s79 offen offset:1024 sc1
    ds_read_b128 v[96:99], v10 offset:128
    ds_read_b128 v[100:103], v11 offset:128
    s_waitcnt vmcnt(7) lgkmcnt(4)
    v_mfma_f32_32x32x16_bf16 v[64:79], v[24:27], v[84:87], v[64:79]
    v_mfma_f32_32x32x16_bf16 v[48:63], v[24:27], v[80:83], v[48:63]
    buffer_load_dwordx4 v[24:27], v4, s[48:51], s79 offen offset:2048 sc1
    ds_read_b128 v[80:83], v10 offset:160
    ds_read_b128 v[84:87], v11 offset:160
    s_waitcnt vmcnt(7) lgkmcnt(4)
    v_mfma_f32_32x32x16_bf16 v[64:79], v[28:31], v[92:95], v[64:79]
    v_mfma_f32_32x32x16_bf16 v[48:63], v[28:31], v[88:91], v[48:63]
    buffer_load_dwordx4 v[28:31], v4, s[48:51], s79 offen offset:3072 sc1
    ds_read_b128 v[88:91], v10 offset:192
    ds_read_b128 v[92:95], v11 offset:192
    s_waitcnt vmcnt(7) lgkmcnt(4)
    v_mfma_f32_32x32x16_bf16 v[64:79], v[32:35], v[100:103], v[64:79]
    v_mfma_f32_32x32x16_bf16 v[48:63], v[32:35], v[96:99], v[48:63]
    s_add_u32 s79, s79, 4096
    buffer_load_dwordx4 v[32:35], v4, s[48:51], s79 offen offset:0 sc1
    ds_read_b128 v[96:99], v10 offset:224
    ds_read_b128 v[100:103], v11 offset:224
    s_waitcnt vmcnt(7) lgkmcnt(4)
    v_mfma_f32_32x32x16_bf16 v[64:79], v[36:39], v[84:87], v[64:79]
    v_mfma_f32_32x32x16_bf16 v[48:63], v[36:39], v[80:83], v[48:63]
    buffer_load_dwordx4 v[36:39], v4, s[48:51], s79 offen offset:1024 sc1
    ds_read_b128 v[80:83], v10 offset:256
    ds_read_b128 v[84:87], v11 offset:256
    s_waitcnt vmcnt(7) lgkmcnt(4)
    v_mfma_f32_32x32x16_bf16 v[64:79], v[40:43], v[92:95], v[64:79]
    v_mfma_f32_32x32x16_bf16 v[48:63], v[40:43], v[88:91], v[48:63]
    buffer_load_dwordx4 v[40:43], v4, s[48:51], s79 offen offset:2048 sc1
    ds_read_b128 v[88:91], v10 offset:288
    ds_read_b128 v[92:95], v11 offset:288
    s_waitcnt vmcnt(7) lgkmcnt(4)
    v_mfma_f32_32x32x16_bf16 v[64:79], v[44:47], v[100:103], v[64:79]
    v_mfma_f32_32x32x16_bf16 v[48:63], v[44:47], v[96:99], v[48:63]
    buffer_load_dwordx4 v[44:47], v4, s[48:51], s79 offen offset:3072 sc1
    ds_read_b128 v[96:99], v10 offset:320
    ds_read_b128 v[100:103], v11 offset:320
    s_waitcnt vmcnt(7) lgkmcnt(4)
    v_mfma_f32_32x32x16_bf16 v[64:79], v[16:19], v[84:87], v[64:79]
    v_mfma_f32_32x32x16_bf16 v[48:63], v[16:19], v[80:83], v[48:63]
    ds_read_b128 v[80:83], v10 offset:352
    ds_read_b128 v[84:87], v11 offset:352
    s_waitcnt vmcnt(6) lgkmcnt(4)
    v_mfma_f32_32x32x16_bf16 v[64:79], v[20:23], v[92:95], v[64:79]
    v_mfma_f32_32x32x16_bf16 v[48:63], v[20:23], v[88:91], v[48:63]
    ds_read_b128 v[88:91], v10 offset:384
    ds_read_b128 v[92:95], v11 offset:384
    s_waitcnt vmcnt(5) lgkmcnt(4)
    v_mfma_f32_32x32x16_bf16 v[64:79], v[24:27], v[100:103], v[64:79]
    v_mfma_f32_32x32x16_bf16 v[48:63], v[24:27], v[96:99], v[48:63]
    ds_read_b128 v[96:99], v10 offset:416
    ds_read_b128 v[100:103], v11 offset:416
    s_waitcnt vmcnt(4) lgkmcnt(4)
    v_mfma_f32_32x32x16_bf16 v[64:79], v[28:31], v[84:87], v[64:79]
    v_mfma_f32_32x32x16_bf16 v[48:63], v[28:31], v[80:83], v[48:63]
    ds_read_b128 v[80:83], v10 offset:448
    ds_read_b128 v[84:87], v11 offset:448
    s_waitcnt vmcnt(3) lgkmcnt(4)
    v_mfma_f32_32x32x16_bf16 v[64:79], v[32:35], v[92:95], v[64:79]
    v_mfma_f32_32x32x16_bf16 v[48:63], v[32:35], v[88:91], v[48:63]
    ds_read_b128 v[88:91], v10 offset:480
    ds_read_b128 v[92:95], v11 offset:480
    s_waitcnt vmcnt(2) lgkmcnt(4)
    v_mfma_f32_32x32x16_bf16 v[64:79], v[36:39], v[100:103], v[64:79]
    v_mfma_f32_32x32x16_bf16 v[48:63], v[36:39], v[96:99], v[48:63]
    s_waitcnt vmcnt(1) lgkmcnt(2)
    v_mfma_f32_32x32x16_bf16 v[64:79], v[40:43], v[84:87], v[64:79]
    v_mfma_f32_32x32x16_bf16 v[48:63], v[40:43], v[80:83], v[48:63]
    s_waitcnt vmcnt(0) lgkmcnt(0)
    v_mfma_f32_32x32x16_bf16 v[64:79], v[44:47], v[92:95], v[64:79]
    v_mfma_f32_32x32x16_bf16 v[48:63], v[44:47], v[88:91], v[48:63]
    s_setprio 3
    s_mov_b32 s75, 0
    L_sy_60:
    ds_read_b32 v125, v0 offset:12
    s_add_u32 s75, s75, 1
    s_waitcnt lgkmcnt(0)
    v_readfirstlane_b32 s68, v125
    s_cmp_ge_u32 s68, 12
    s_cbranch_scc1 L_syd_61
    s_cmp_lt_u32 s75, 200000
    s_cbranch_scc1 L_sy_60
    L_syd_61:
    s_nop 3
    ds_write_b128 v119, v[64:67] offset:0
    ds_write_b128 v119, v[68:71] offset:1024
    ds_write_b128 v119, v[72:75] offset:2048
    ds_write_b128 v119, v[76:79] offset:3072
    s_waitcnt lgkmcnt(0)
    s_mov_b64 exec, 1
    ds_add_u32 v0, v124 offset:0
    s_mov_b64 exec, -1
    s_mov_b32 s75, 0
    L_sy_62:
    ds_read_b32 v125, v0 offset:0
    s_add_u32 s75, s75, 1
    s_waitcnt lgkmcnt(0)
    v_readfirstlane_b32 s68, v125
    s_cmp_ge_u32 s68, 42
    s_cbranch_scc1 L_syd_63
    s_cmp_lt_u32 s75, 200000
    s_cbranch_scc1 L_sy_62
    L_syd_63:
    ds_read_b128 v[64:67], v120 offset:0
    ds_read_b128 v[68:71], v120 offset:1024
    ds_read_b128 v[72:75], v120 offset:2048
    ds_read_b128 v[76:79], v120 offset:3072
    s_waitcnt lgkmcnt(3)
    v_add_f32 v48, v48, v64
    s_mov_b32 s69, 0
    buffer_store_dword v48, v113, s[44:47], s69 offen nt
    v_add_f32 v49, v49, v65
    s_mov_b32 s69, 32768
    buffer_store_dword v49, v113, s[44:47], s69 offen nt
    v_add_f32 v50, v50, v66
    s_mov_b32 s69, 4096
    buffer_store_dword v50, v113, s[44:47], s69 offen nt
    v_add_f32 v51, v51, v67
    s_mov_b32 s69, 36864
    buffer_store_dword v51, v113, s[44:47], s69 offen nt
    s_waitcnt lgkmcnt(2)
    v_add_f32 v52, v52, v68
    s_mov_b32 s69, 16384
    buffer_store_dword v52, v113, s[44:47], s69 offen nt
    v_add_f32 v53, v53, v69
    s_mov_b32 s69, 49152
    buffer_store_dword v53, v113, s[44:47], s69 offen nt
    v_add_f32 v54, v54, v70
    s_mov_b32 s69, 20480
    buffer_store_dword v54, v113, s[44:47], s69 offen nt
    v_add_f32 v55, v55, v71
    s_mov_b32 s69, 53248
    buffer_store_dword v55, v113, s[44:47], s69 offen nt
    s_waitcnt lgkmcnt(1)
    v_add_f32 v56, v56, v72
    s_mov_b32 s69, 65536
    buffer_store_dword v56, v113, s[44:47], s69 offen nt
    v_add_f32 v57, v57, v73
    s_mov_b32 s69, 98304
    buffer_store_dword v57, v113, s[44:47], s69 offen nt
    v_add_f32 v58, v58, v74
    s_mov_b32 s69, 69632
    buffer_store_dword v58, v113, s[44:47], s69 offen nt
    v_add_f32 v59, v59, v75
    s_mov_b32 s69, 102400
    buffer_store_dword v59, v113, s[44:47], s69 offen nt
    s_waitcnt lgkmcnt(0)
    v_add_f32 v60, v60, v76
    s_mov_b32 s69, 81920
    buffer_store_dword v60, v113, s[44:47], s69 offen nt
    v_add_f32 v61, v61, v77
    s_mov_b32 s69, 114688
    buffer_store_dword v61, v113, s[44:47], s69 offen nt
    v_add_f32 v62, v62, v78
    s_mov_b32 s69, 86016
    buffer_store_dword v62, v113, s[44:47], s69 offen nt
    v_add_f32 v63, v63, v79
    s_mov_b32 s69, 118784
    buffer_store_dword v63, v113, s[44:47], s69 offen nt
    s_mov_b32 s75, 0
    L_sy_64:
    ds_read_b32 v125, v0 offset:24
    s_add_u32 s75, s75, 1
    s_waitcnt lgkmcnt(0)
    v_readfirstlane_b32 s68, v125
    s_cmp_ge_u32 s68, 6
    s_cbranch_scc1 L_syd_65
    s_cmp_lt_u32 s75, 200000
    s_cbranch_scc1 L_sy_64
    L_syd_65:
    s_add_u32 s69, s82, 0
    buffer_load_dwordx4 v[16:19], v4, s[48:51], s69 offen offset:0 sc1
    buffer_load_dwordx4 v[20:23], v4, s[48:51], s69 offen offset:1024 sc1
    buffer_load_dwordx4 v[24:27], v4, s[48:51], s69 offen offset:2048 sc1
    buffer_load_dwordx4 v[28:31], v4, s[48:51], s69 offen offset:3072 sc1
    s_add_u32 s69, s82, 8192
    buffer_load_dwordx4 v[32:35], v4, s[48:51], s69 offen offset:0 sc1
    buffer_load_dwordx4 v[36:39], v4, s[48:51], s69 offen offset:1024 sc1
    buffer_load_dwordx4 v[40:43], v4, s[48:51], s69 offen offset:2048 sc1
    buffer_load_dwordx4 v[44:47], v4, s[48:51], s69 offen offset:3072 sc1
    s_add_u32 s69, s82, 16384
    buffer_load_dwordx4 v[80:83], v4, s[48:51], s69 offen offset:0 sc1
    buffer_load_dwordx4 v[84:87], v4, s[48:51], s69 offen offset:1024 sc1
    buffer_load_dwordx4 v[88:91], v4, s[48:51], s69 offen offset:2048 sc1
    buffer_load_dwordx4 v[92:95], v4, s[48:51], s69 offen offset:3072 sc1
    s_add_u32 s69, s82, 24576
    buffer_load_dwordx4 v[96:99], v4, s[48:51], s69 offen offset:0 sc1
    buffer_load_dwordx4 v[100:103], v4, s[48:51], s69 offen offset:1024 sc1
    buffer_load_dwordx4 v[104:107], v4, s[48:51], s69 offen offset:2048 sc1
    buffer_load_dwordx4 v[108:111], v4, s[48:51], s69 offen offset:3072 sc1
    s_mov_b32 s75, 0
    s_waitcnt vmcnt(12)
L_opc_68:
    v_max_u32 v13, v17, v19
    v_max3_u32 v13, v13, v21, v23
    v_max3_u32 v13, v13, v25, v27
    v_max3_u32 v13, v13, v29, v31
    v_cmp_eq_u32 vcc, -1, v13
    s_cbranch_vccz L_opd_67
    s_add_u32 s75, s75, 1
    s_cmp_gt_u32 s75, 20000
    s_cbranch_scc1 L_opd_67
    s_add_u32 s69, s82, 0
    buffer_load_dwordx4 v[16:19], v4, s[48:51], s69 offen offset:0 sc1
    buffer_load_dwordx4 v[20:23], v4, s[48:51], s69 offen offset:1024 sc1
    buffer_load_dwordx4 v[24:27], v4, s[48:51], s69 offen offset:2048 sc1
    buffer_load_dwordx4 v[28:31], v4, s[48:51], s69 offen offset:3072 sc1
    s_waitcnt vmcnt(0)
    s_branch L_opc_68
    L_opd_67:
    v_mfma_f32_32x32x16_bf16 v[64:79], v[16:19], a[4:7], 0
    v_mfma_f32_32x32x16_bf16 v[48:63], v[16:19], a[0:3], 0
    v_mfma_f32_32x32x16_bf16 v[64:79], v[20:23], a[12:15], v[64:79]
    v_mfma_f32_32x32x16_bf16 v[48:63], v[20:23], a[8:11], v[48:63]
    v_mfma_f32_32x32x16_bf16 v[64:79], v[24:27], a[20:23], v[64:79]
    v_mfma_f32_32x32x16_bf16 v[48:63], v[24:27], a[16:19], v[48:63]
    v_mfma_f32_32x32x16_bf16 v[64:79], v[28:31], a[28:31], v[64:79]
    v_mfma_f32_32x32x16_bf16 v[48:63], v[28:31], a[24:27], v[48:63]
    s_waitcnt vmcnt(8)
L_opc_71:
    v_max_u32 v13, v33, v35
    v_max3_u32 v13, v13, v37, v39
    v_max3_u32 v13, v13, v41, v43
    v_max3_u32 v13, v13, v45, v47
    v_cmp_eq_u32 vcc, -1, v13
    s_cbranch_vccz L_opd_70
    s_add_u32 s75, s75, 1
    s_cmp_gt_u32 s75, 20000
    s_cbranch_scc1 L_opd_70
    s_add_u32 s69, s82, 8192
    buffer_load_dwordx4 v[32:35], v4, s[48:51], s69 offen offset:0 sc1
    buffer_load_dwordx4 v[36:39], v4, s[48:51], s69 offen offset:1024 sc1
    buffer_load_dwordx4 v[40:43], v4, s[48:51], s69 offen offset:2048 sc1
    buffer_load_dwordx4 v[44:47], v4, s[48:51], s69 offen offset:3072 sc1
    s_waitcnt vmcnt(0)
    s_branch L_opc_71
    L_opd_70:
    v_mfma_f32_32x32x16_bf16 v[64:79], v[32:35], a[36:39], v[64:79]
    v_mfma_f32_32x32x16_bf16 v[48:63], v[32:35], a[32:35], v[48:63]
    v_mfma_f32_32x32x16_bf16 v[64:79], v[36:39], a[44:47], v[64:79]
    v_mfma_f32_32x32x16_bf16 v[48:63], v[36:39], a[40:43], v[48:63]
    v_mfma_f32_32x32x16_bf16 v[64:79], v[40:43], a[52:55], v[64:79]
    v_mfma_f32_32x32x16_bf16 v[48:63], v[40:43], a[48:51], v[48:63]
    v_mfma_f32_32x32x16_bf16 v[64:79], v[44:47], a[60:63], v[64:79]
    v_mfma_f32_32x32x16_bf16 v[48:63], v[44:47], a[56:59], v[48:63]
    s_waitcnt vmcnt(4)
L_opc_74:
    v_max_u32 v13, v81, v83
    v_max3_u32 v13, v13, v85, v87
    v_max3_u32 v13, v13, v89, v91
    v_max3_u32 v13, v13, v93, v95
    v_cmp_eq_u32 vcc, -1, v13
    s_cbranch_vccz L_opd_73
    s_add_u32 s75, s75, 1
    s_cmp_gt_u32 s75, 20000
    s_cbranch_scc1 L_opd_73
    s_add_u32 s69, s82, 16384
    buffer_load_dwordx4 v[80:83], v4, s[48:51], s69 offen offset:0 sc1
    buffer_load_dwordx4 v[84:87], v4, s[48:51], s69 offen offset:1024 sc1
    buffer_load_dwordx4 v[88:91], v4, s[48:51], s69 offen offset:2048 sc1
    buffer_load_dwordx4 v[92:95], v4, s[48:51], s69 offen offset:3072 sc1
    s_waitcnt vmcnt(0)
    s_branch L_opc_74
    L_opd_73:
    v_mfma_f32_32x32x16_bf16 v[64:79], v[80:83], a[68:71], v[64:79]
    v_mfma_f32_32x32x16_bf16 v[48:63], v[80:83], a[64:67], v[48:63]
    v_mfma_f32_32x32x16_bf16 v[64:79], v[84:87], a[76:79], v[64:79]
    v_mfma_f32_32x32x16_bf16 v[64:79], v[88:91], a[84:87], v[64:79]
    v_mfma_f32_32x32x16_bf16 v[64:79], v[92:95], a[92:95], v[64:79]
    s_waitcnt vmcnt(0)
L_opc_77:
    v_max_u32 v13, v97, v99
    v_max3_u32 v13, v13, v101, v103
    v_max3_u32 v13, v13, v105, v107
    v_max3_u32 v13, v13, v109, v111
    v_cmp_eq_u32 vcc, -1, v13
    s_cbranch_vccz L_opd_76
    s_add_u32 s75, s75, 1
    s_cmp_gt_u32 s75, 20000
    s_cbranch_scc1 L_opd_76
    s_add_u32 s69, s82, 24576
    buffer_load_dwordx4 v[96:99], v4, s[48:51], s69 offen offset:0 sc1
    buffer_load_dwordx4 v[100:103], v4, s[48:51], s69 offen offset:1024 sc1
    buffer_load_dwordx4 v[104:107], v4, s[48:51], s69 offen offset:2048 sc1
    buffer_load_dwordx4 v[108:111], v4, s[48:51], s69 offen offset:3072 sc1
    s_waitcnt vmcnt(0)
    s_branch L_opc_77
    L_opd_76:
    v_mfma_f32_32x32x16_bf16 v[64:79], v[96:99], a[100:103], v[64:79]
    v_mfma_f32_32x32x16_bf16 v[64:79], v[100:103], a[108:111], v[64:79]
    v_mfma_f32_32x32x16_bf16 v[64:79], v[104:107], a[116:119], v[64:79]
    v_mfma_f32_32x32x16_bf16 v[64:79], v[108:111], a[124:127], v[64:79]
    v_mfma_f32_32x32x16_bf16 v[48:63], v[84:87], a[72:75], v[48:63]
    v_mfma_f32_32x32x16_bf16 v[48:63], v[88:91], a[80:83], v[48:63]
    v_mfma_f32_32x32x16_bf16 v[48:63], v[92:95], a[88:91], v[48:63]
    s_nop 8
    ds_write_b128 v114, v[64:67] offset:0
    ds_write_b128 v114, v[68:71] offset:1024
    ds_write_b128 v114, v[72:75] offset:2048
    ds_write_b128 v114, v[76:79] offset:3072
    v_mfma_f32_32x32x16_bf16 v[48:63], v[96:99], a[96:99], v[48:63]
    v_mfma_f32_32x32x16_bf16 v[48:63], v[100:103], a[104:107], v[48:63]
    v_mfma_f32_32x32x16_bf16 v[48:63], v[104:107], a[112:115], v[48:63]
    v_mfma_f32_32x32x16_bf16 v[48:63], v[108:111], a[120:123], v[48:63]
    s_waitcnt lgkmcnt(0)
    s_barrier
    ds_read_b128 v[64:67], v115 offset:0
    ds_read_b128 v[68:71], v115 offset:1024
    ds_read_b128 v[72:75], v115 offset:2048
    ds_read_b128 v[76:79], v115 offset:3072
    s_nop 5
    s_waitcnt lgkmcnt(3)
    v_add_f32 v48, v48, v64
    s_mov_b32 s69, 0
    buffer_store_dword v48, v118, s[44:47], s69 offen nt
    v_add_f32 v49, v49, v65
    s_mov_b32 s69, 4096
    buffer_store_dword v49, v118, s[44:47], s69 offen nt
    v_add_f32 v50, v50, v66
    s_mov_b32 s69, 8192
    buffer_store_dword v50, v118, s[44:47], s69 offen nt
    v_add_f32 v51, v51, v67
    s_mov_b32 s69, 12288
    buffer_store_dword v51, v118, s[44:47], s69 offen nt
    s_waitcnt lgkmcnt(2)
    v_add_f32 v52, v52, v68
    s_mov_b32 s69, 32768
    buffer_store_dword v52, v118, s[44:47], s69 offen nt
    v_add_f32 v53, v53, v69
    s_mov_b32 s69, 36864
    buffer_store_dword v53, v118, s[44:47], s69 offen nt
    v_add_f32 v54, v54, v70
    s_mov_b32 s69, 40960
    buffer_store_dword v54, v118, s[44:47], s69 offen nt
    v_add_f32 v55, v55, v71
    s_mov_b32 s69, 45056
    buffer_store_dword v55, v118, s[44:47], s69 offen nt
    s_waitcnt lgkmcnt(1)
    v_add_f32 v56, v56, v72
    s_mov_b32 s69, 65536
    buffer_store_dword v56, v118, s[44:47], s69 offen nt
    v_add_f32 v57, v57, v73
    s_mov_b32 s69, 69632
    buffer_store_dword v57, v118, s[44:47], s69 offen nt
    v_add_f32 v58, v58, v74
    s_mov_b32 s69, 73728
    buffer_store_dword v58, v118, s[44:47], s69 offen nt
    v_add_f32 v59, v59, v75
    s_mov_b32 s69, 77824
    buffer_store_dword v59, v118, s[44:47], s69 offen nt
    s_waitcnt lgkmcnt(0)
    v_add_f32 v60, v60, v76
    s_mov_b32 s69, 98304
    buffer_store_dword v60, v118, s[44:47], s69 offen nt
    v_add_f32 v61, v61, v77
    s_mov_b32 s69, 102400
    buffer_store_dword v61, v118, s[44:47], s69 offen nt
    v_add_f32 v62, v62, v78
    s_mov_b32 s69, 106496
    buffer_store_dword v62, v118, s[44:47], s69 offen nt
    v_add_f32 v63, v63, v79
    s_mov_b32 s69, 110592
    buffer_store_dword v63, v118, s[44:47], s69 offen nt
    s_branch L_fin
L_hot_end:
L_slow:
    s_cmp_lg_u32 s67, 0
    s_cbranch_scc1 L_fast
    s_mov_b32 s67, 1
    s_waitcnt lgkmcnt(0)
    v_mov_b32 v120, 0
    v_mov_b32 v121, 0
    v_mov_b32 v122, 0
    v_mov_b32 v123, 0
    v_mov_b32 v104, 0xff800000
    v_mov_b32 v105, 0xff800000
    v_mov_b32 v106, 0xff800000
    v_mov_b32 v107, 0xff800000
    v_mov_b32 v108, 0xff800000
    v_mov_b32 v109, 0xff800000
    v_mov_b32 v110, 0xff800000
    v_mov_b32 v111, 0xff800000
    s_nop 1
    v_mfma_f32_32x32x16_bf16 a[0:15], v[120:123], v[120:123], 0
    v_mfma_f32_32x32x16_bf16 a[16:31], v[120:123], v[120:123], 0
    v_mfma_f32_32x32x16_bf16 a[32:47], v[120:123], v[120:123], 0
    v_mfma_f32_32x32x16_bf16 a[48:63], v[120:123], v[120:123], 0
    v_mfma_f32_32x32x16_bf16 a[64:79], v[120:123], v[120:123], 0
    v_mfma_f32_32x32x16_bf16 a[80:95], v[120:123], v[120:123], 0
    v_mfma_f32_32x32x16_bf16 a[96:111], v[120:123], v[120:123], 0
    v_mfma_f32_32x32x16_bf16 a[112:127], v[120:123], v[120:123], 0
    s_mov_b32 s78, 16
    s_mov_b32 s72, 1052289595
L_sl1:
    buffer_load_dwordx4 v[80:83], v5, s[48:51], s79 offen offset:2560 sc1
    s_add_u32 s79, s79, 4096
    s_and_b32 s79, s79, 0xffff
    s_waitcnt vmcnt(0)
    v_mfma_f32_32x32x16_bf16 v[16:31], v[80:83], v[48:51], 0
    s_nop 11
    v_cvt_pk_bf16_f32 v17, v16, v17
    v_lshlrev_b32 v16, 16, v17
    v_and_b32 v17, 0xffff0000, v17
    v_cvt_pk_bf16_f32 v19, v18, v19
    v_lshlrev_b32 v18, 16, v19
    v_and_b32 v19, 0xffff0000, v19
    v_cvt_pk_bf16_f32 v21, v20, v21
    v_lshlrev_b32 v20, 16, v21
    v_and_b32 v21, 0xffff0000, v21
    v_cvt_pk_bf16_f32 v23, v22, v23
    v_lshlrev_b32 v22, 16, v23
    v_and_b32 v23, 0xffff0000, v23
    v_cvt_pk_bf16_f32 v25, v24, v25
    v_lshlrev_b32 v24, 16, v25
    v_and_b32 v25, 0xffff0000, v25
    v_cvt_pk_bf16_f32 v27, v26, v27
    v_lshlrev_b32 v26, 16, v27
    v_and_b32 v27, 0xffff0000, v27
    v_cvt_pk_bf16_f32 v29, v28, v29
    v_lshlrev_b32 v28, 16, v29
    v_and_b32 v29, 0xffff0000, v29
    v_cvt_pk_bf16_f32 v31, v30, v31
    v_lshlrev_b32 v30, 16, v31
    v_and_b32 v31, 0xffff0000, v31
    v_max3_f32 v104, v16, v17, v104
    v_max3_f32 v104, v18, v19, v104
    v_max3_f32 v104, v20, v21, v104
    v_max3_f32 v104, v22, v23, v104
    v_max3_f32 v104, v24, v25, v104
    v_max3_f32 v104, v26, v27, v104
    v_max3_f32 v104, v28, v29, v104
    v_max3_f32 v104, v30, v31, v104
    v_mfma_f32_32x32x16_bf16 v[16:31], v[80:83], v[52:55], 0
    s_nop 11
    v_cvt_pk_bf16_f32 v17, v16, v17
    v_lshlrev_b32 v16, 16, v17
    v_and_b32 v17, 0xffff0000, v17
    v_cvt_pk_bf16_f32 v19, v18, v19
    v_lshlrev_b32 v18, 16, v19
    v_and_b32 v19, 0xffff0000, v19
    v_cvt_pk_bf16_f32 v21, v20, v21
    v_lshlrev_b32 v20, 16, v21
    v_and_b32 v21, 0xffff0000, v21
    v_cvt_pk_bf16_f32 v23, v22, v23
    v_lshlrev_b32 v22, 16, v23
    v_and_b32 v23, 0xffff0000, v23
    v_cvt_pk_bf16_f32 v25, v24, v25
    v_lshlrev_b32 v24, 16, v25
    v_and_b32 v25, 0xffff0000, v25
    v_cvt_pk_bf16_f32 v27, v26, v27
    v_lshlrev_b32 v26, 16, v27
    v_and_b32 v27, 0xffff0000, v27
    v_cvt_pk_bf16_f32 v29, v28, v29
    v_lshlrev_b32 v28, 16, v29
    v_and_b32 v29, 0xffff0000, v29
    v_cvt_pk_bf16_f32 v31, v30, v31
    v_lshlrev_b32 v30, 16, v31
    v_and_b32 v31, 0xffff0000, v31
    v_max3_f32 v105, v16, v17, v105
    v_max3_f32 v105, v18, v19, v105
    v_max3_f32 v105, v20, v21, v105
    v_max3_f32 v105, v22, v23, v105
    v_max3_f32 v105, v24, v25, v105
    v_max3_f32 v105, v26, v27, v105
    v_max3_f32 v105, v28, v29, v105
    v_max3_f32 v105, v30, v31, v105
    v_mfma_f32_32x32x16_bf16 v[16:31], v[80:83], v[56:59], 0
    s_nop 11
    v_cvt_pk_bf16_f32 v17, v16, v17
    v_lshlrev_b32 v16, 16, v17
    v_and_b32 v17, 0xffff0000, v17
    v_cvt_pk_bf16_f32 v19, v18, v19
    v_lshlrev_b32 v18, 16, v19
    v_and_b32 v19, 0xffff0000, v19
    v_cvt_pk_bf16_f32 v21, v20, v21
    v_lshlrev_b32 v20, 16, v21
    v_and_b32 v21, 0xffff0000, v21
    v_cvt_pk_bf16_f32 v23, v22, v23
    v_lshlrev_b32 v22, 16, v23
    v_and_b32 v23, 0xffff0000, v23
    v_cvt_pk_bf16_f32 v25, v24, v25
    v_lshlrev_b32 v24, 16, v25
    v_and_b32 v25, 0xffff0000, v25
    v_cvt_pk_bf16_f32 v27, v26, v27
    v_lshlrev_b32 v26, 16, v27
    v_and_b32 v27, 0xffff0000, v27
    v_cvt_pk_bf16_f32 v29, v28, v29
    v_lshlrev_b32 v28, 16, v29
    v_and_b32 v29, 0xffff0000, v29
    v_cvt_pk_bf16_f32 v31, v30, v31
    v_lshlrev_b32 v30, 16, v31
    v_and_b32 v31, 0xffff0000, v31
    v_max3_f32 v106, v16, v17, v106
    v_max3_f32 v106, v18, v19, v106
    v_max3_f32 v106, v20, v21, v106
    v_max3_f32 v106, v22, v23, v106
    v_max3_f32 v106, v24, v25, v106
    v_max3_f32 v106, v26, v27, v106
    v_max3_f32 v106, v28, v29, v106
    v_max3_f32 v106, v30, v31, v106
    v_mfma_f32_32x32x16_bf16 v[16:31], v[80:83], v[60:63], 0
    s_nop 11
    v_cvt_pk_bf16_f32 v17, v16, v17
    v_lshlrev_b32 v16, 16, v17
    v_and_b32 v17, 0xffff0000, v17
    v_cvt_pk_bf16_f32 v19, v18, v19
    v_lshlrev_b32 v18, 16, v19
    v_and_b32 v19, 0xffff0000, v19
    v_cvt_pk_bf16_f32 v21, v20, v21
    v_lshlrev_b32 v20, 16, v21
    v_and_b32 v21, 0xffff0000, v21
    v_cvt_pk_bf16_f32 v23, v22, v23
    v_lshlrev_b32 v22, 16, v23
    v_and_b32 v23, 0xffff0000, v23
    v_cvt_pk_bf16_f32 v25, v24, v25
    v_lshlrev_b32 v24, 16, v25
    v_and_b32 v25, 0xffff0000, v25
    v_cvt_pk_bf16_f32 v27, v26, v27
    v_lshlrev_b32 v26, 16, v27
    v_and_b32 v27, 0xffff0000, v27
    v_cvt_pk_bf16_f32 v29, v28, v29
    v_lshlrev_b32 v28, 16, v29
    v_and_b32 v29, 0xffff0000, v29
    v_cvt_pk_bf16_f32 v31, v30, v31
    v_lshlrev_b32 v30, 16, v31
    v_and_b32 v31, 0xffff0000, v31
    v_max3_f32 v107, v16, v17, v107
    v_max3_f32 v107, v18, v19, v107
    v_max3_f32 v107, v20, v21, v107
    v_max3_f32 v107, v22, v23, v107
    v_max3_f32 v107, v24, v25, v107
    v_max3_f32 v107, v26, v27, v107
    v_max3_f32 v107, v28, v29, v107
    v_max3_f32 v107, v30, v31, v107
    v_mfma_f32_32x32x16_bf16 v[16:31], v[80:83], v[64:67], 0
    s_nop 11
    v_cvt_pk_bf16_f32 v17, v16, v17
    v_lshlrev_b32 v16, 16, v17
    v_and_b32 v17, 0xffff0000, v17
    v_cvt_pk_bf16_f32 v19, v18, v19
    v_lshlrev_b32 v18, 16, v19
    v_and_b32 v19, 0xffff0000, v19
    v_cvt_pk_bf16_f32 v21, v20, v21
    v_lshlrev_b32 v20, 16, v21
    v_and_b32 v21, 0xffff0000, v21
    v_cvt_pk_bf16_f32 v23, v22, v23
    v_lshlrev_b32 v22, 16, v23
    v_and_b32 v23, 0xffff0000, v23
    v_cvt_pk_bf16_f32 v25, v24, v25
    v_lshlrev_b32 v24, 16, v25
    v_and_b32 v25, 0xffff0000, v25
    v_cvt_pk_bf16_f32 v27, v26, v27
    v_lshlrev_b32 v26, 16, v27
    v_and_b32 v27, 0xffff0000, v27
    v_cvt_pk_bf16_f32 v29, v28, v29
    v_lshlrev_b32 v28, 16, v29
    v_and_b32 v29, 0xffff0000, v29
    v_cvt_pk_bf16_f32 v31, v30, v31
    v_lshlrev_b32 v30, 16, v31
    v_and_b32 v31, 0xffff0000, v31
    v_max3_f32 v108, v16, v17, v108
    v_max3_f32 v108, v18, v19, v108
    v_max3_f32 v108, v20, v21, v108
    v_max3_f32 v108, v22, v23, v108
    v_max3_f32 v108, v24, v25, v108
    v_max3_f32 v108, v26, v27, v108
    v_max3_f32 v108, v28, v29, v108
    v_max3_f32 v108, v30, v31, v108
    v_mfma_f32_32x32x16_bf16 v[16:31], v[80:83], v[68:71], 0
    s_nop 11
    v_cvt_pk_bf16_f32 v17, v16, v17
    v_lshlrev_b32 v16, 16, v17
    v_and_b32 v17, 0xffff0000, v17
    v_cvt_pk_bf16_f32 v19, v18, v19
    v_lshlrev_b32 v18, 16, v19
    v_and_b32 v19, 0xffff0000, v19
    v_cvt_pk_bf16_f32 v21, v20, v21
    v_lshlrev_b32 v20, 16, v21
    v_and_b32 v21, 0xffff0000, v21
    v_cvt_pk_bf16_f32 v23, v22, v23
    v_lshlrev_b32 v22, 16, v23
    v_and_b32 v23, 0xffff0000, v23
    v_cvt_pk_bf16_f32 v25, v24, v25
    v_lshlrev_b32 v24, 16, v25
    v_and_b32 v25, 0xffff0000, v25
    v_cvt_pk_bf16_f32 v27, v26, v27
    v_lshlrev_b32 v26, 16, v27
    v_and_b32 v27, 0xffff0000, v27
    v_cvt_pk_bf16_f32 v29, v28, v29
    v_lshlrev_b32 v28, 16, v29
    v_and_b32 v29, 0xffff0000, v29
    v_cvt_pk_bf16_f32 v31, v30, v31
    v_lshlrev_b32 v30, 16, v31
    v_and_b32 v31, 0xffff0000, v31
    v_max3_f32 v109, v16, v17, v109
    v_max3_f32 v109, v18, v19, v109
    v_max3_f32 v109, v20, v21, v109
    v_max3_f32 v109, v22, v23, v109
    v_max3_f32 v109, v24, v25, v109
    v_max3_f32 v109, v26, v27, v109
    v_max3_f32 v109, v28, v29, v109
    v_max3_f32 v109, v30, v31, v109
    v_mfma_f32_32x32x16_bf16 v[16:31], v[80:83], v[72:75], 0
    s_nop 11
    v_cvt_pk_bf16_f32 v17, v16, v17
    v_lshlrev_b32 v16, 16, v17
    v_and_b32 v17, 0xffff0000, v17
    v_cvt_pk_bf16_f32 v19, v18, v19
    v_lshlrev_b32 v18, 16, v19
    v_and_b32 v19, 0xffff0000, v19
    v_cvt_pk_bf16_f32 v21, v20, v21
    v_lshlrev_b32 v20, 16, v21
    v_and_b32 v21, 0xffff0000, v21
    v_cvt_pk_bf16_f32 v23, v22, v23
    v_lshlrev_b32 v22, 16, v23
    v_and_b32 v23, 0xffff0000, v23
    v_cvt_pk_bf16_f32 v25, v24, v25
    v_lshlrev_b32 v24, 16, v25
    v_and_b32 v25, 0xffff0000, v25
    v_cvt_pk_bf16_f32 v27, v26, v27
    v_lshlrev_b32 v26, 16, v27
    v_and_b32 v27, 0xffff0000, v27
    v_cvt_pk_bf16_f32 v29, v28, v29
    v_lshlrev_b32 v28, 16, v29
    v_and_b32 v29, 0xffff0000, v29
    v_cvt_pk_bf16_f32 v31, v30, v31
    v_lshlrev_b32 v30, 16, v31
    v_and_b32 v31, 0xffff0000, v31
    v_max3_f32 v110, v16, v17, v110
    v_max3_f32 v110, v18, v19, v110
    v_max3_f32 v110, v20, v21, v110
    v_max3_f32 v110, v22, v23, v110
    v_max3_f32 v110, v24, v25, v110
    v_max3_f32 v110, v26, v27, v110
    v_max3_f32 v110, v28, v29, v110
    v_max3_f32 v110, v30, v31, v110
    v_mfma_f32_32x32x16_bf16 v[16:31], v[80:83], v[76:79], 0
    s_nop 11
    v_cvt_pk_bf16_f32 v17, v16, v17
    v_lshlrev_b32 v16, 16, v17
    v_and_b32 v17, 0xffff0000, v17
    v_cvt_pk_bf16_f32 v19, v18, v19
    v_lshlrev_b32 v18, 16, v19
    v_and_b32 v19, 0xffff0000, v19
    v_cvt_pk_bf16_f32 v21, v20, v21
    v_lshlrev_b32 v20, 16, v21
    v_and_b32 v21, 0xffff0000, v21
    v_cvt_pk_bf16_f32 v23, v22, v23
    v_lshlrev_b32 v22, 16, v23
    v_and_b32 v23, 0xffff0000, v23
    v_cvt_pk_bf16_f32 v25, v24, v25
    v_lshlrev_b32 v24, 16, v25
    v_and_b32 v25, 0xffff0000, v25
    v_cvt_pk_bf16_f32 v27, v26, v27
    v_lshlrev_b32 v26, 16, v27
    v_and_b32 v27, 0xffff0000, v27
    v_cvt_pk_bf16_f32 v29, v28, v29
    v_lshlrev_b32 v28, 16, v29
    v_and_b32 v29, 0xffff0000, v29
    v_cvt_pk_bf16_f32 v31, v30, v31
    v_lshlrev_b32 v30, 16, v31
    v_and_b32 v31, 0xffff0000, v31
    v_max3_f32 v111, v16, v17, v111
    v_max3_f32 v111, v18, v19, v111
    v_max3_f32 v111, v20, v21, v111
    v_max3_f32 v111, v22, v23, v111
    v_max3_f32 v111, v24, v25, v111
    v_max3_f32 v111, v26, v27, v111
    v_max3_f32 v111, v28, v29, v111
    v_max3_f32 v111, v30, v31, v111
    s_sub_u32 s78, s78, 1
    s_cmp_lg_u32 s78, 0
    s_cbranch_scc1 L_sl1
    s_lshl_b32 s68, s3, 11
    s_add_u32 s68, s68, 105472
    v_lshlrev_b32 v8, 2, v1
    v_add_u32 v8, s68, v8
    v_lshlrev_b32 v10, 2, v2
    v_add_u32 v10, 105472, v10
    s_add_u32 s65, s65, 4
    s_waitcnt lgkmcnt(0)
    s_mov_b64 exec, 1
    ds_inc_u32 v0, v7 offset:4
    s_mov_b64 exec, -1
    s_mov_b32 s75, 0
    L_sy_78:
    ds_read_b32 v16, v0 offset:4
    s_add_u32 s75, s75, 1
    s_waitcnt lgkmcnt(0)
    v_readfirstlane_b32 s68, v16
    s_cmp_ge_u32 s68, s65
    s_cbranch_scc1 L_syd_79
    s_sleep 2
    s_cmp_lt_u32 s75, 200000
    s_cbranch_scc1 L_sy_78
    L_syd_79:
    s_add_u32 s68, s3, 1
    s_and_b32 s68, s68, 3
    s_lshl_b32 s68, s68, 9
    v_add_u32 v9, s68, v8
    ds_write_b32 v9, v104
    ds_write_b32 v9, v105 offset:256
    s_add_u32 s68, s3, 2
    s_and_b32 s68, s68, 3
    s_lshl_b32 s68, s68, 9
    v_add_u32 v9, s68, v8
    ds_write_b32 v9, v106
    ds_write_b32 v9, v107 offset:256
    s_add_u32 s68, s3, 3
    s_and_b32 s68, s68, 3
    s_lshl_b32 s68, s68, 9
    v_add_u32 v9, s68, v8
    ds_write_b32 v9, v108
    ds_write_b32 v9, v109 offset:256
    s_add_u32 s68, s3, 4
    s_and_b32 s68, s68, 3
    s_lshl_b32 s68, s68, 9
    v_add_u32 v9, s68, v8
    ds_write_b32 v9, v110
    ds_write_b32 v9, v111 offset:256
    s_add_u32 s65, s65, 4
    s_waitcnt lgkmcnt(0)
    s_mov_b64 exec, 1
    ds_inc_u32 v0, v7 offset:4
    s_mov_b64 exec, -1
    s_mov_b32 s75, 0
    L_sy_80:
    ds_read_b32 v16, v0 offset:4
    s_add_u32 s75, s75, 1
    s_waitcnt lgkmcnt(0)
    v_readfirstlane_b32 s68, v16
    s_cmp_ge_u32 s68, s65
    s_cbranch_scc1 L_syd_81
    s_sleep 2
    s_cmp_lt_u32 s75, 200000
    s_cbranch_scc1 L_sy_80
    L_syd_81:
    s_add_u32 s68, s3, 1
    s_and_b32 s68, s68, 3
    s_lshl_b32 s68, s68, 9
    v_add_u32 v9, s68, v10
    ds_read_b32 v16, v9 offset:0
    ds_read_b32 v17, v9 offset:128
    ds_read_b32 v18, v9 offset:2048
    ds_read_b32 v19, v9 offset:2176
    ds_read_b32 v20, v9 offset:4096
    ds_read_b32 v21, v9 offset:4224
    ds_read_b32 v22, v9 offset:6144
    ds_read_b32 v23, v9 offset:6272
    s_waitcnt lgkmcnt(0)
    v_max3_f32 v104, v16, v17, v104
    v_max3_f32 v104, v18, v19, v104
    v_max3_f32 v104, v20, v21, v104
    v_max3_f32 v104, v22, v23, v104
    ds_read_b32 v16, v9 offset:256
    ds_read_b32 v17, v9 offset:384
    ds_read_b32 v18, v9 offset:2304
    ds_read_b32 v19, v9 offset:2432
    ds_read_b32 v20, v9 offset:4352
    ds_read_b32 v21, v9 offset:4480
    ds_read_b32 v22, v9 offset:6400
    ds_read_b32 v23, v9 offset:6528
    s_waitcnt lgkmcnt(0)
    v_max3_f32 v105, v16, v17, v105
    v_max3_f32 v105, v18, v19, v105
    v_max3_f32 v105, v20, v21, v105
    v_max3_f32 v105, v22, v23, v105
    s_add_u32 s68, s3, 2
    s_and_b32 s68, s68, 3
    s_lshl_b32 s68, s68, 9
    v_add_u32 v9, s68, v10
    ds_read_b32 v16, v9 offset:0
    ds_read_b32 v17, v9 offset:128
    ds_read_b32 v18, v9 offset:2048
    ds_read_b32 v19, v9 offset:2176
    ds_read_b32 v20, v9 offset:4096
    ds_read_b32 v21, v9 offset:4224
    ds_read_b32 v22, v9 offset:6144
    ds_read_b32 v23, v9 offset:6272
    s_waitcnt lgkmcnt(0)
    v_max3_f32 v106, v16, v17, v106
    v_max3_f32 v106, v18, v19, v106
    v_max3_f32 v106, v20, v21, v106
    v_max3_f32 v106, v22, v23, v106
    ds_read_b32 v16, v9 offset:256
    ds_read_b32 v17, v9 offset:384
    ds_read_b32 v18, v9 offset:2304
    ds_read_b32 v19, v9 offset:2432
    ds_read_b32 v20, v9 offset:4352
    ds_read_b32 v21, v9 offset:4480
    ds_read_b32 v22, v9 offset:6400
    ds_read_b32 v23, v9 offset:6528
    s_waitcnt lgkmcnt(0)
    v_max3_f32 v107, v16, v17, v107
    v_max3_f32 v107, v18, v19, v107
    v_max3_f32 v107, v20, v21, v107
    v_max3_f32 v107, v22, v23, v107
    s_add_u32 s68, s3, 3
    s_and_b32 s68, s68, 3
    s_lshl_b32 s68, s68, 9
    v_add_u32 v9, s68, v10
    ds_read_b32 v16, v9 offset:0
    ds_read_b32 v17, v9 offset:128
    ds_read_b32 v18, v9 offset:2048
    ds_read_b32 v19, v9 offset:2176
    ds_read_b32 v20, v9 offset:4096
    ds_read_b32 v21, v9 offset:4224
    ds_read_b32 v22, v9 offset:6144
    ds_read_b32 v23, v9 offset:6272
    s_waitcnt lgkmcnt(0)
    v_max3_f32 v108, v16, v17, v108
    v_max3_f32 v108, v18, v19, v108
    v_max3_f32 v108, v20, v21, v108
    v_max3_f32 v108, v22, v23, v108
    ds_read_b32 v16, v9 offset:256
    ds_read_b32 v17, v9 offset:384
    ds_read_b32 v18, v9 offset:2304
    ds_read_b32 v19, v9 offset:2432
    ds_read_b32 v20, v9 offset:4352
    ds_read_b32 v21, v9 offset:4480
    ds_read_b32 v22, v9 offset:6400
    ds_read_b32 v23, v9 offset:6528
    s_waitcnt lgkmcnt(0)
    v_max3_f32 v109, v16, v17, v109
    v_max3_f32 v109, v18, v19, v109
    v_max3_f32 v109, v20, v21, v109
    v_max3_f32 v109, v22, v23, v109
    s_add_u32 s68, s3, 4
    s_and_b32 s68, s68, 3
    s_lshl_b32 s68, s68, 9
    v_add_u32 v9, s68, v10
    ds_read_b32 v16, v9 offset:0
    ds_read_b32 v17, v9 offset:128
    ds_read_b32 v18, v9 offset:2048
    ds_read_b32 v19, v9 offset:2176
    ds_read_b32 v20, v9 offset:4096
    ds_read_b32 v21, v9 offset:4224
    ds_read_b32 v22, v9 offset:6144
    ds_read_b32 v23, v9 offset:6272
    s_waitcnt lgkmcnt(0)
    v_max3_f32 v110, v16, v17, v110
    v_max3_f32 v110, v18, v19, v110
    v_max3_f32 v110, v20, v21, v110
    v_max3_f32 v110, v22, v23, v110
    ds_read_b32 v16, v9 offset:256
    ds_read_b32 v17, v9 offset:384
    ds_read_b32 v18, v9 offset:2304
    ds_read_b32 v19, v9 offset:2432
    ds_read_b32 v20, v9 offset:4352
    ds_read_b32 v21, v9 offset:4480
    ds_read_b32 v22, v9 offset:6400
    ds_read_b32 v23, v9 offset:6528
    s_waitcnt lgkmcnt(0)
    v_max3_f32 v111, v16, v17, v111
    v_max3_f32 v111, v18, v19, v111
    v_max3_f32 v111, v20, v21, v111
    v_max3_f32 v111, v22, v23, v111
    s_add_u32 s65, s65, 4
    s_waitcnt lgkmcnt(0)
    s_mov_b64 exec, 1
    ds_inc_u32 v0, v7 offset:4
    s_mov_b64 exec, -1
    s_mov_b32 s75, 0
    L_sy_82:
    ds_read_b32 v16, v0 offset:4
    s_add_u32 s75, s75, 1
    s_waitcnt lgkmcnt(0)
    v_readfirstlane_b32 s68, v16
    s_cmp_ge_u32 s68, s65
    s_cbranch_scc1 L_syd_83
    s_sleep 2
    s_cmp_lt_u32 s75, 200000
    s_cbranch_scc1 L_sy_82
    L_syd_83:
    s_mov_b32 s78, 16
L_sl2:
    buffer_load_dwordx4 v[80:83], v5, s[48:51], s79 offen offset:2560 sc1
    buffer_load_dwordx4 v[84:87], v6, s[48:51], s79 offen offset:0 sc1
    buffer_load_dwordx4 v[88:91], v6, s[48:51], s79 offen offset:544 sc1
    s_add_u32 s79, s79, 4096
    s_and_b32 s79, s79, 0xffff
    s_waitcnt vmcnt(0)
    v_mfma_f32_32x32x16_bf16 v[16:31], v[80:83], v[48:51], 0
    s_nop 11
    v_cvt_pk_bf16_f32 v17, v16, v17
    v_lshlrev_b32 v16, 16, v17
    v_and_b32 v17, 0xffff0000, v17
    v_cvt_pk_bf16_f32 v19, v18, v19
    v_lshlrev_b32 v18, 16, v19
    v_and_b32 v19, 0xffff0000, v19
    v_cvt_pk_bf16_f32 v21, v20, v21
    v_lshlrev_b32 v20, 16, v21
    v_and_b32 v21, 0xffff0000, v21
    v_cvt_pk_bf16_f32 v23, v22, v23
    v_lshlrev_b32 v22, 16, v23
    v_and_b32 v23, 0xffff0000, v23
    v_cvt_pk_bf16_f32 v25, v24, v25
    v_lshlrev_b32 v24, 16, v25
    v_and_b32 v25, 0xffff0000, v25
    v_cvt_pk_bf16_f32 v27, v26, v27
    v_lshlrev_b32 v26, 16, v27
    v_and_b32 v27, 0xffff0000, v27
    v_cvt_pk_bf16_f32 v29, v28, v29
    v_lshlrev_b32 v28, 16, v29
    v_and_b32 v29, 0xffff0000, v29
    v_cvt_pk_bf16_f32 v31, v30, v31
    v_lshlrev_b32 v30, 16, v31
    v_and_b32 v31, 0xffff0000, v31
    v_sub_f32 v16, v16, v104
    v_sub_f32 v17, v17, v104
    v_sub_f32 v18, v18, v104
    v_sub_f32 v19, v19, v104
    v_sub_f32 v20, v20, v104
    v_sub_f32 v21, v21, v104
    v_sub_f32 v22, v22, v104
    v_sub_f32 v23, v23, v104
    v_sub_f32 v24, v24, v104
    v_sub_f32 v25, v25, v104
    v_sub_f32 v26, v26, v104
    v_sub_f32 v27, v27, v104
    v_sub_f32 v28, v28, v104
    v_sub_f32 v29, v29, v104
    v_sub_f32 v30, v30, v104
    v_sub_f32 v31, v31, v104
    v_mul_f32 v16, s72, v16
    v_mul_f32 v17, s72, v17
    v_mul_f32 v18, s72, v18
    v_mul_f32 v19, s72, v19
    v_mul_f32 v20, s72, v20
    v_mul_f32 v21, s72, v21
    v_mul_f32 v22, s72, v22
    v_mul_f32 v23, s72, v23
    v_mul_f32 v24, s72, v24
    v_mul_f32 v25, s72, v25
    v_mul_f32 v26, s72, v26
    v_mul_f32 v27, s72, v27
    v_mul_f32 v28, s72, v28
    v_mul_f32 v29, s72, v29
    v_mul_f32 v30, s72, v30
    v_mul_f32 v31, s72, v31
    v_exp_f32 v16, v16
    v_exp_f32 v17, v17
    v_exp_f32 v18, v18
    v_exp_f32 v19, v19
    v_exp_f32 v20, v20
    v_exp_f32 v21, v21
    v_exp_f32 v22, v22
    v_exp_f32 v23, v23
    v_exp_f32 v24, v24
    v_exp_f32 v25, v25
    v_exp_f32 v26, v26
    v_exp_f32 v27, v27
    v_exp_f32 v28, v28
    v_exp_f32 v29, v29
    v_exp_f32 v30, v30
    v_exp_f32 v31, v31
    s_nop 1
    v_smfmac_f32_32x32x32_bf16 a[0:15], v[84:87], v[16:23], v7
    v_smfmac_f32_32x32x32_bf16 a[0:15], v[88:91], v[24:31], v7
    v_mfma_f32_32x32x16_bf16 v[16:31], v[80:83], v[52:55], 0
    s_nop 11
    v_cvt_pk_bf16_f32 v17, v16, v17
    v_lshlrev_b32 v16, 16, v17
    v_and_b32 v17, 0xffff0000, v17
    v_cvt_pk_bf16_f32 v19, v18, v19
    v_lshlrev_b32 v18, 16, v19
    v_and_b32 v19, 0xffff0000, v19
    v_cvt_pk_bf16_f32 v21, v20, v21
    v_lshlrev_b32 v20, 16, v21
    v_and_b32 v21, 0xffff0000, v21
    v_cvt_pk_bf16_f32 v23, v22, v23
    v_lshlrev_b32 v22, 16, v23
    v_and_b32 v23, 0xffff0000, v23
    v_cvt_pk_bf16_f32 v25, v24, v25
    v_lshlrev_b32 v24, 16, v25
    v_and_b32 v25, 0xffff0000, v25
    v_cvt_pk_bf16_f32 v27, v26, v27
    v_lshlrev_b32 v26, 16, v27
    v_and_b32 v27, 0xffff0000, v27
    v_cvt_pk_bf16_f32 v29, v28, v29
    v_lshlrev_b32 v28, 16, v29
    v_and_b32 v29, 0xffff0000, v29
    v_cvt_pk_bf16_f32 v31, v30, v31
    v_lshlrev_b32 v30, 16, v31
    v_and_b32 v31, 0xffff0000, v31
    v_sub_f32 v16, v16, v105
    v_sub_f32 v17, v17, v105
    v_sub_f32 v18, v18, v105
    v_sub_f32 v19, v19, v105
    v_sub_f32 v20, v20, v105
    v_sub_f32 v21, v21, v105
    v_sub_f32 v22, v22, v105
    v_sub_f32 v23, v23, v105
    v_sub_f32 v24, v24, v105
    v_sub_f32 v25, v25, v105
    v_sub_f32 v26, v26, v105
    v_sub_f32 v27, v27, v105
    v_sub_f32 v28, v28, v105
    v_sub_f32 v29, v29, v105
    v_sub_f32 v30, v30, v105
    v_sub_f32 v31, v31, v105
    v_mul_f32 v16, s72, v16
    v_mul_f32 v17, s72, v17
    v_mul_f32 v18, s72, v18
    v_mul_f32 v19, s72, v19
    v_mul_f32 v20, s72, v20
    v_mul_f32 v21, s72, v21
    v_mul_f32 v22, s72, v22
    v_mul_f32 v23, s72, v23
    v_mul_f32 v24, s72, v24
    v_mul_f32 v25, s72, v25
    v_mul_f32 v26, s72, v26
    v_mul_f32 v27, s72, v27
    v_mul_f32 v28, s72, v28
    v_mul_f32 v29, s72, v29
    v_mul_f32 v30, s72, v30
    v_mul_f32 v31, s72, v31
    v_exp_f32 v16, v16
    v_exp_f32 v17, v17
    v_exp_f32 v18, v18
    v_exp_f32 v19, v19
    v_exp_f32 v20, v20
    v_exp_f32 v21, v21
    v_exp_f32 v22, v22
    v_exp_f32 v23, v23
    v_exp_f32 v24, v24
    v_exp_f32 v25, v25
    v_exp_f32 v26, v26
    v_exp_f32 v27, v27
    v_exp_f32 v28, v28
    v_exp_f32 v29, v29
    v_exp_f32 v30, v30
    v_exp_f32 v31, v31
    s_nop 1
    v_smfmac_f32_32x32x32_bf16 a[16:31], v[84:87], v[16:23], v7
    v_smfmac_f32_32x32x32_bf16 a[16:31], v[88:91], v[24:31], v7
    v_mfma_f32_32x32x16_bf16 v[16:31], v[80:83], v[56:59], 0
    s_nop 11
    v_cvt_pk_bf16_f32 v17, v16, v17
    v_lshlrev_b32 v16, 16, v17
    v_and_b32 v17, 0xffff0000, v17
    v_cvt_pk_bf16_f32 v19, v18, v19
    v_lshlrev_b32 v18, 16, v19
    v_and_b32 v19, 0xffff0000, v19
    v_cvt_pk_bf16_f32 v21, v20, v21
    v_lshlrev_b32 v20, 16, v21
    v_and_b32 v21, 0xffff0000, v21
    v_cvt_pk_bf16_f32 v23, v22, v23
    v_lshlrev_b32 v22, 16, v23
    v_and_b32 v23, 0xffff0000, v23
    v_cvt_pk_bf16_f32 v25, v24, v25
    v_lshlrev_b32 v24, 16, v25
    v_and_b32 v25, 0xffff0000, v25
    v_cvt_pk_bf16_f32 v27, v26, v27
    v_lshlrev_b32 v26, 16, v27
    v_and_b32 v27, 0xffff0000, v27
    v_cvt_pk_bf16_f32 v29, v28, v29
    v_lshlrev_b32 v28, 16, v29
    v_and_b32 v29, 0xffff0000, v29
    v_cvt_pk_bf16_f32 v31, v30, v31
    v_lshlrev_b32 v30, 16, v31
    v_and_b32 v31, 0xffff0000, v31
    v_sub_f32 v16, v16, v106
    v_sub_f32 v17, v17, v106
    v_sub_f32 v18, v18, v106
    v_sub_f32 v19, v19, v106
    v_sub_f32 v20, v20, v106
    v_sub_f32 v21, v21, v106
    v_sub_f32 v22, v22, v106
    v_sub_f32 v23, v23, v106
    v_sub_f32 v24, v24, v106
    v_sub_f32 v25, v25, v106
    v_sub_f32 v26, v26, v106
    v_sub_f32 v27, v27, v106
    v_sub_f32 v28, v28, v106
    v_sub_f32 v29, v29, v106
    v_sub_f32 v30, v30, v106
    v_sub_f32 v31, v31, v106
    v_mul_f32 v16, s72, v16
    v_mul_f32 v17, s72, v17
    v_mul_f32 v18, s72, v18
    v_mul_f32 v19, s72, v19
    v_mul_f32 v20, s72, v20
    v_mul_f32 v21, s72, v21
    v_mul_f32 v22, s72, v22
    v_mul_f32 v23, s72, v23
    v_mul_f32 v24, s72, v24
    v_mul_f32 v25, s72, v25
    v_mul_f32 v26, s72, v26
    v_mul_f32 v27, s72, v27
    v_mul_f32 v28, s72, v28
    v_mul_f32 v29, s72, v29
    v_mul_f32 v30, s72, v30
    v_mul_f32 v31, s72, v31
    v_exp_f32 v16, v16
    v_exp_f32 v17, v17
    v_exp_f32 v18, v18
    v_exp_f32 v19, v19
    v_exp_f32 v20, v20
    v_exp_f32 v21, v21
    v_exp_f32 v22, v22
    v_exp_f32 v23, v23
    v_exp_f32 v24, v24
    v_exp_f32 v25, v25
    v_exp_f32 v26, v26
    v_exp_f32 v27, v27
    v_exp_f32 v28, v28
    v_exp_f32 v29, v29
    v_exp_f32 v30, v30
    v_exp_f32 v31, v31
    s_nop 1
    v_smfmac_f32_32x32x32_bf16 a[32:47], v[84:87], v[16:23], v7
    v_smfmac_f32_32x32x32_bf16 a[32:47], v[88:91], v[24:31], v7
    v_mfma_f32_32x32x16_bf16 v[16:31], v[80:83], v[60:63], 0
    s_nop 11
    v_cvt_pk_bf16_f32 v17, v16, v17
    v_lshlrev_b32 v16, 16, v17
    v_and_b32 v17, 0xffff0000, v17
    v_cvt_pk_bf16_f32 v19, v18, v19
    v_lshlrev_b32 v18, 16, v19
    v_and_b32 v19, 0xffff0000, v19
    v_cvt_pk_bf16_f32 v21, v20, v21
    v_lshlrev_b32 v20, 16, v21
    v_and_b32 v21, 0xffff0000, v21
    v_cvt_pk_bf16_f32 v23, v22, v23
    v_lshlrev_b32 v22, 16, v23
    v_and_b32 v23, 0xffff0000, v23
    v_cvt_pk_bf16_f32 v25, v24, v25
    v_lshlrev_b32 v24, 16, v25
    v_and_b32 v25, 0xffff0000, v25
    v_cvt_pk_bf16_f32 v27, v26, v27
    v_lshlrev_b32 v26, 16, v27
    v_and_b32 v27, 0xffff0000, v27
    v_cvt_pk_bf16_f32 v29, v28, v29
    v_lshlrev_b32 v28, 16, v29
    v_and_b32 v29, 0xffff0000, v29
    v_cvt_pk_bf16_f32 v31, v30, v31
    v_lshlrev_b32 v30, 16, v31
    v_and_b32 v31, 0xffff0000, v31
    v_sub_f32 v16, v16, v107
    v_sub_f32 v17, v17, v107
    v_sub_f32 v18, v18, v107
    v_sub_f32 v19, v19, v107
    v_sub_f32 v20, v20, v107
    v_sub_f32 v21, v21, v107
    v_sub_f32 v22, v22, v107
    v_sub_f32 v23, v23, v107
    v_sub_f32 v24, v24, v107
    v_sub_f32 v25, v25, v107
    v_sub_f32 v26, v26, v107
    v_sub_f32 v27, v27, v107
    v_sub_f32 v28, v28, v107
    v_sub_f32 v29, v29, v107
    v_sub_f32 v30, v30, v107
    v_sub_f32 v31, v31, v107
    v_mul_f32 v16, s72, v16
    v_mul_f32 v17, s72, v17
    v_mul_f32 v18, s72, v18
    v_mul_f32 v19, s72, v19
    v_mul_f32 v20, s72, v20
    v_mul_f32 v21, s72, v21
    v_mul_f32 v22, s72, v22
    v_mul_f32 v23, s72, v23
    v_mul_f32 v24, s72, v24
    v_mul_f32 v25, s72, v25
    v_mul_f32 v26, s72, v26
    v_mul_f32 v27, s72, v27
    v_mul_f32 v28, s72, v28
    v_mul_f32 v29, s72, v29
    v_mul_f32 v30, s72, v30
    v_mul_f32 v31, s72, v31
    v_exp_f32 v16, v16
    v_exp_f32 v17, v17
    v_exp_f32 v18, v18
    v_exp_f32 v19, v19
    v_exp_f32 v20, v20
    v_exp_f32 v21, v21
    v_exp_f32 v22, v22
    v_exp_f32 v23, v23
    v_exp_f32 v24, v24
    v_exp_f32 v25, v25
    v_exp_f32 v26, v26
    v_exp_f32 v27, v27
    v_exp_f32 v28, v28
    v_exp_f32 v29, v29
    v_exp_f32 v30, v30
    v_exp_f32 v31, v31
    s_nop 1
    v_smfmac_f32_32x32x32_bf16 a[48:63], v[84:87], v[16:23], v7
    v_smfmac_f32_32x32x32_bf16 a[48:63], v[88:91], v[24:31], v7
    v_mfma_f32_32x32x16_bf16 v[16:31], v[80:83], v[64:67], 0
    s_nop 11
    v_cvt_pk_bf16_f32 v17, v16, v17
    v_lshlrev_b32 v16, 16, v17
    v_and_b32 v17, 0xffff0000, v17
    v_cvt_pk_bf16_f32 v19, v18, v19
    v_lshlrev_b32 v18, 16, v19
    v_and_b32 v19, 0xffff0000, v19
    v_cvt_pk_bf16_f32 v21, v20, v21
    v_lshlrev_b32 v20, 16, v21
    v_and_b32 v21, 0xffff0000, v21
    v_cvt_pk_bf16_f32 v23, v22, v23
    v_lshlrev_b32 v22, 16, v23
    v_and_b32 v23, 0xffff0000, v23
    v_cvt_pk_bf16_f32 v25, v24, v25
    v_lshlrev_b32 v24, 16, v25
    v_and_b32 v25, 0xffff0000, v25
    v_cvt_pk_bf16_f32 v27, v26, v27
    v_lshlrev_b32 v26, 16, v27
    v_and_b32 v27, 0xffff0000, v27
    v_cvt_pk_bf16_f32 v29, v28, v29
    v_lshlrev_b32 v28, 16, v29
    v_and_b32 v29, 0xffff0000, v29
    v_cvt_pk_bf16_f32 v31, v30, v31
    v_lshlrev_b32 v30, 16, v31
    v_and_b32 v31, 0xffff0000, v31
    v_sub_f32 v16, v16, v108
    v_sub_f32 v17, v17, v108
    v_sub_f32 v18, v18, v108
    v_sub_f32 v19, v19, v108
    v_sub_f32 v20, v20, v108
    v_sub_f32 v21, v21, v108
    v_sub_f32 v22, v22, v108
    v_sub_f32 v23, v23, v108
    v_sub_f32 v24, v24, v108
    v_sub_f32 v25, v25, v108
    v_sub_f32 v26, v26, v108
    v_sub_f32 v27, v27, v108
    v_sub_f32 v28, v28, v108
    v_sub_f32 v29, v29, v108
    v_sub_f32 v30, v30, v108
    v_sub_f32 v31, v31, v108
    v_mul_f32 v16, s72, v16
    v_mul_f32 v17, s72, v17
    v_mul_f32 v18, s72, v18
    v_mul_f32 v19, s72, v19
    v_mul_f32 v20, s72, v20
    v_mul_f32 v21, s72, v21
    v_mul_f32 v22, s72, v22
    v_mul_f32 v23, s72, v23
    v_mul_f32 v24, s72, v24
    v_mul_f32 v25, s72, v25
    v_mul_f32 v26, s72, v26
    v_mul_f32 v27, s72, v27
    v_mul_f32 v28, s72, v28
    v_mul_f32 v29, s72, v29
    v_mul_f32 v30, s72, v30
    v_mul_f32 v31, s72, v31
    v_exp_f32 v16, v16
    v_exp_f32 v17, v17
    v_exp_f32 v18, v18
    v_exp_f32 v19, v19
    v_exp_f32 v20, v20
    v_exp_f32 v21, v21
    v_exp_f32 v22, v22
    v_exp_f32 v23, v23
    v_exp_f32 v24, v24
    v_exp_f32 v25, v25
    v_exp_f32 v26, v26
    v_exp_f32 v27, v27
    v_exp_f32 v28, v28
    v_exp_f32 v29, v29
    v_exp_f32 v30, v30
    v_exp_f32 v31, v31
    s_nop 1
    v_smfmac_f32_32x32x32_bf16 a[64:79], v[84:87], v[16:23], v7
    v_smfmac_f32_32x32x32_bf16 a[64:79], v[88:91], v[24:31], v7
    v_mfma_f32_32x32x16_bf16 v[16:31], v[80:83], v[68:71], 0
    s_nop 11
    v_cvt_pk_bf16_f32 v17, v16, v17
    v_lshlrev_b32 v16, 16, v17
    v_and_b32 v17, 0xffff0000, v17
    v_cvt_pk_bf16_f32 v19, v18, v19
    v_lshlrev_b32 v18, 16, v19
    v_and_b32 v19, 0xffff0000, v19
    v_cvt_pk_bf16_f32 v21, v20, v21
    v_lshlrev_b32 v20, 16, v21
    v_and_b32 v21, 0xffff0000, v21
    v_cvt_pk_bf16_f32 v23, v22, v23
    v_lshlrev_b32 v22, 16, v23
    v_and_b32 v23, 0xffff0000, v23
    v_cvt_pk_bf16_f32 v25, v24, v25
    v_lshlrev_b32 v24, 16, v25
    v_and_b32 v25, 0xffff0000, v25
    v_cvt_pk_bf16_f32 v27, v26, v27
    v_lshlrev_b32 v26, 16, v27
    v_and_b32 v27, 0xffff0000, v27
    v_cvt_pk_bf16_f32 v29, v28, v29
    v_lshlrev_b32 v28, 16, v29
    v_and_b32 v29, 0xffff0000, v29
    v_cvt_pk_bf16_f32 v31, v30, v31
    v_lshlrev_b32 v30, 16, v31
    v_and_b32 v31, 0xffff0000, v31
    v_sub_f32 v16, v16, v109
    v_sub_f32 v17, v17, v109
    v_sub_f32 v18, v18, v109
    v_sub_f32 v19, v19, v109
    v_sub_f32 v20, v20, v109
    v_sub_f32 v21, v21, v109
    v_sub_f32 v22, v22, v109
    v_sub_f32 v23, v23, v109
    v_sub_f32 v24, v24, v109
    v_sub_f32 v25, v25, v109
    v_sub_f32 v26, v26, v109
    v_sub_f32 v27, v27, v109
    v_sub_f32 v28, v28, v109
    v_sub_f32 v29, v29, v109
    v_sub_f32 v30, v30, v109
    v_sub_f32 v31, v31, v109
    v_mul_f32 v16, s72, v16
    v_mul_f32 v17, s72, v17
    v_mul_f32 v18, s72, v18
    v_mul_f32 v19, s72, v19
    v_mul_f32 v20, s72, v20
    v_mul_f32 v21, s72, v21
    v_mul_f32 v22, s72, v22
    v_mul_f32 v23, s72, v23
    v_mul_f32 v24, s72, v24
    v_mul_f32 v25, s72, v25
    v_mul_f32 v26, s72, v26
    v_mul_f32 v27, s72, v27
    v_mul_f32 v28, s72, v28
    v_mul_f32 v29, s72, v29
    v_mul_f32 v30, s72, v30
    v_mul_f32 v31, s72, v31
    v_exp_f32 v16, v16
    v_exp_f32 v17, v17
    v_exp_f32 v18, v18
    v_exp_f32 v19, v19
    v_exp_f32 v20, v20
    v_exp_f32 v21, v21
    v_exp_f32 v22, v22
    v_exp_f32 v23, v23
    v_exp_f32 v24, v24
    v_exp_f32 v25, v25
    v_exp_f32 v26, v26
    v_exp_f32 v27, v27
    v_exp_f32 v28, v28
    v_exp_f32 v29, v29
    v_exp_f32 v30, v30
    v_exp_f32 v31, v31
    s_nop 1
    v_smfmac_f32_32x32x32_bf16 a[80:95], v[84:87], v[16:23], v7
    v_smfmac_f32_32x32x32_bf16 a[80:95], v[88:91], v[24:31], v7
    v_mfma_f32_32x32x16_bf16 v[16:31], v[80:83], v[72:75], 0
    s_nop 11
    v_cvt_pk_bf16_f32 v17, v16, v17
    v_lshlrev_b32 v16, 16, v17
    v_and_b32 v17, 0xffff0000, v17
    v_cvt_pk_bf16_f32 v19, v18, v19
    v_lshlrev_b32 v18, 16, v19
    v_and_b32 v19, 0xffff0000, v19
    v_cvt_pk_bf16_f32 v21, v20, v21
    v_lshlrev_b32 v20, 16, v21
    v_and_b32 v21, 0xffff0000, v21
    v_cvt_pk_bf16_f32 v23, v22, v23
    v_lshlrev_b32 v22, 16, v23
    v_and_b32 v23, 0xffff0000, v23
    v_cvt_pk_bf16_f32 v25, v24, v25
    v_lshlrev_b32 v24, 16, v25
    v_and_b32 v25, 0xffff0000, v25
    v_cvt_pk_bf16_f32 v27, v26, v27
    v_lshlrev_b32 v26, 16, v27
    v_and_b32 v27, 0xffff0000, v27
    v_cvt_pk_bf16_f32 v29, v28, v29
    v_lshlrev_b32 v28, 16, v29
    v_and_b32 v29, 0xffff0000, v29
    v_cvt_pk_bf16_f32 v31, v30, v31
    v_lshlrev_b32 v30, 16, v31
    v_and_b32 v31, 0xffff0000, v31
    v_sub_f32 v16, v16, v110
    v_sub_f32 v17, v17, v110
    v_sub_f32 v18, v18, v110
    v_sub_f32 v19, v19, v110
    v_sub_f32 v20, v20, v110
    v_sub_f32 v21, v21, v110
    v_sub_f32 v22, v22, v110
    v_sub_f32 v23, v23, v110
    v_sub_f32 v24, v24, v110
    v_sub_f32 v25, v25, v110
    v_sub_f32 v26, v26, v110
    v_sub_f32 v27, v27, v110
    v_sub_f32 v28, v28, v110
    v_sub_f32 v29, v29, v110
    v_sub_f32 v30, v30, v110
    v_sub_f32 v31, v31, v110
    v_mul_f32 v16, s72, v16
    v_mul_f32 v17, s72, v17
    v_mul_f32 v18, s72, v18
    v_mul_f32 v19, s72, v19
    v_mul_f32 v20, s72, v20
    v_mul_f32 v21, s72, v21
    v_mul_f32 v22, s72, v22
    v_mul_f32 v23, s72, v23
    v_mul_f32 v24, s72, v24
    v_mul_f32 v25, s72, v25
    v_mul_f32 v26, s72, v26
    v_mul_f32 v27, s72, v27
    v_mul_f32 v28, s72, v28
    v_mul_f32 v29, s72, v29
    v_mul_f32 v30, s72, v30
    v_mul_f32 v31, s72, v31
    v_exp_f32 v16, v16
    v_exp_f32 v17, v17
    v_exp_f32 v18, v18
    v_exp_f32 v19, v19
    v_exp_f32 v20, v20
    v_exp_f32 v21, v21
    v_exp_f32 v22, v22
    v_exp_f32 v23, v23
    v_exp_f32 v24, v24
    v_exp_f32 v25, v25
    v_exp_f32 v26, v26
    v_exp_f32 v27, v27
    v_exp_f32 v28, v28
    v_exp_f32 v29, v29
    v_exp_f32 v30, v30
    v_exp_f32 v31, v31
    s_nop 1
    v_smfmac_f32_32x32x32_bf16 a[96:111], v[84:87], v[16:23], v7
    v_smfmac_f32_32x32x32_bf16 a[96:111], v[88:91], v[24:31], v7
    v_mfma_f32_32x32x16_bf16 v[16:31], v[80:83], v[76:79], 0
    s_nop 11
    v_cvt_pk_bf16_f32 v17, v16, v17
    v_lshlrev_b32 v16, 16, v17
    v_and_b32 v17, 0xffff0000, v17
    v_cvt_pk_bf16_f32 v19, v18, v19
    v_lshlrev_b32 v18, 16, v19
    v_and_b32 v19, 0xffff0000, v19
    v_cvt_pk_bf16_f32 v21, v20, v21
    v_lshlrev_b32 v20, 16, v21
    v_and_b32 v21, 0xffff0000, v21
    v_cvt_pk_bf16_f32 v23, v22, v23
    v_lshlrev_b32 v22, 16, v23
    v_and_b32 v23, 0xffff0000, v23
    v_cvt_pk_bf16_f32 v25, v24, v25
    v_lshlrev_b32 v24, 16, v25
    v_and_b32 v25, 0xffff0000, v25
    v_cvt_pk_bf16_f32 v27, v26, v27
    v_lshlrev_b32 v26, 16, v27
    v_and_b32 v27, 0xffff0000, v27
    v_cvt_pk_bf16_f32 v29, v28, v29
    v_lshlrev_b32 v28, 16, v29
    v_and_b32 v29, 0xffff0000, v29
    v_cvt_pk_bf16_f32 v31, v30, v31
    v_lshlrev_b32 v30, 16, v31
    v_and_b32 v31, 0xffff0000, v31
    v_sub_f32 v16, v16, v111
    v_sub_f32 v17, v17, v111
    v_sub_f32 v18, v18, v111
    v_sub_f32 v19, v19, v111
    v_sub_f32 v20, v20, v111
    v_sub_f32 v21, v21, v111
    v_sub_f32 v22, v22, v111
    v_sub_f32 v23, v23, v111
    v_sub_f32 v24, v24, v111
    v_sub_f32 v25, v25, v111
    v_sub_f32 v26, v26, v111
    v_sub_f32 v27, v27, v111
    v_sub_f32 v28, v28, v111
    v_sub_f32 v29, v29, v111
    v_sub_f32 v30, v30, v111
    v_sub_f32 v31, v31, v111
    v_mul_f32 v16, s72, v16
    v_mul_f32 v17, s72, v17
    v_mul_f32 v18, s72, v18
    v_mul_f32 v19, s72, v19
    v_mul_f32 v20, s72, v20
    v_mul_f32 v21, s72, v21
    v_mul_f32 v22, s72, v22
    v_mul_f32 v23, s72, v23
    v_mul_f32 v24, s72, v24
    v_mul_f32 v25, s72, v25
    v_mul_f32 v26, s72, v26
    v_mul_f32 v27, s72, v27
    v_mul_f32 v28, s72, v28
    v_mul_f32 v29, s72, v29
    v_mul_f32 v30, s72, v30
    v_mul_f32 v31, s72, v31
    v_exp_f32 v16, v16
    v_exp_f32 v17, v17
    v_exp_f32 v18, v18
    v_exp_f32 v19, v19
    v_exp_f32 v20, v20
    v_exp_f32 v21, v21
    v_exp_f32 v22, v22
    v_exp_f32 v23, v23
    v_exp_f32 v24, v24
    v_exp_f32 v25, v25
    v_exp_f32 v26, v26
    v_exp_f32 v27, v27
    v_exp_f32 v28, v28
    v_exp_f32 v29, v29
    v_exp_f32 v30, v30
    v_exp_f32 v31, v31
    s_nop 1
    v_smfmac_f32_32x32x32_bf16 a[112:127], v[84:87], v[16:23], v7
    v_smfmac_f32_32x32x32_bf16 a[112:127], v[88:91], v[24:31], v7
    s_sub_u32 s78, s78, 1
    s_cmp_lg_u32 s78, 0
    s_cbranch_scc1 L_sl2
    s_nop 15
    ds_write_b128 v11, a[0:3] offset:27648
    ds_write_b128 v11, a[4:7] offset:28672
    ds_write_b32 v13, a8 offset:29696
    ds_write_b128 v11, a[16:19] offset:29952
    ds_write_b128 v11, a[20:23] offset:30976
    ds_write_b32 v13, a24 offset:32000
    ds_write_b128 v11, a[32:35] offset:32256
    ds_write_b128 v11, a[36:39] offset:33280
    ds_write_b32 v13, a40 offset:34304
    ds_write_b128 v11, a[48:51] offset:0
    ds_write_b128 v11, a[52:55] offset:1024
    ds_write_b32 v13, a56 offset:2048
    ds_write_b128 v11, a[64:67] offset:2304
    ds_write_b128 v11, a[68:71] offset:3328
    ds_write_b32 v13, a72 offset:4352
    ds_write_b128 v11, a[80:83] offset:4608
    ds_write_b128 v11, a[84:87] offset:5632
    ds_write_b32 v13, a88 offset:6656
    s_waitcnt lgkmcnt(0)
    s_mov_b64 exec, 1
    ds_inc_u32 v0, v7 offset:4
    s_mov_b64 exec, -1
    s_add_u32 s65, s65, 4
    s_add_u32 s68, s3, 1
    s_and_b32 s68, s68, 3
    s_mul_i32 s68, s68, 6912
    s_add_u32 s68, s68, 105472
    v_add_u32 v8, s68, v4
    v_lshl_add_u32 v12, v2, 2, s68
    s_add_u32 s68, s3, 2
    s_and_b32 s68, s68, 3
    s_mul_i32 s68, s68, 6912
    s_add_u32 s68, s68, 105472
    v_add_u32 v9, s68, v4
    v_lshl_add_u32 v14, v2, 2, s68
    s_add_u32 s68, s3, 3
    s_and_b32 s68, s68, 3
    s_mul_i32 s68, s68, 6912
    s_add_u32 s68, s68, 105472
    v_add_u32 v10, s68, v4
    v_lshl_add_u32 v15, v2, 2, s68
    s_lshl_b32 s69, s5, 2
    s_add_u32 s69, s69, s3
    s_lshl_b32 s69, s69, 10
    s_lshl_b32 s70, s4, 16
    s_add_u32 s69, s69, s70
    s_add_u32 s69, s69, 1048576
    s_add_u32 s70, s69, 32768
    s_waitcnt vmcnt(0)
    s_mov_b32 s75, 0
    L_sy_84:
    ds_read_b32 v16, v0 offset:4
    s_add_u32 s75, s75, 1
    s_waitcnt lgkmcnt(0)
    v_readfirstlane_b32 s68, v16
    s_cmp_ge_u32 s68, s65
    s_cbranch_scc1 L_syd_85
    s_cmp_lt_u32 s75, 200000
    s_cbranch_scc1 L_sy_84
    L_syd_85:
    ds_read_b64 v[118:119], v0 offset:16
    ds_read_b32 v112, v12 offset:4352
    ds_read_b32 v113, v14 offset:34304
    ds_read_b32 v114, v15 offset:29696
    ds_read_b128 v[16:19], v8 offset:2304
    ds_read_b128 v[20:23], v8 offset:3328
    ds_read_b128 v[24:27], v9 offset:32256
    ds_read_b128 v[28:31], v9 offset:33280
    ds_read_b128 v[80:83], v10 offset:27648
    ds_read_b128 v[84:87], v10 offset:28672
    s_waitcnt lgkmcnt(6)
    ds_read_b32 v115, v12 offset:6656
    ds_read_b32 v116, v14 offset:2048
    ds_read_b32 v117, v15 offset:32000
    ds_read_b128 v[88:91], v8 offset:4608
    ds_read_b128 v[92:95], v8 offset:5632
    ds_read_b128 v[96:99], v9 offset:0
    ds_read_b128 v[100:103], v9 offset:1024
    ds_read_b128 v[104:107], v10 offset:29952
    ds_read_b128 v[108:111], v10 offset:30976
    s_branch L_comb2
.section .rodata,"a"
.p2align 6
.amdhsa_kernel concat_heads__ssm_conv_s5__grouped_kv_mqa__prompt_kernel
  .amdhsa_next_free_vgpr 256
  .amdhsa_next_free_sgpr 102
  .amdhsa_accum_offset 128
  .amdhsa_group_segment_fixed_size 0
  .amdhsa_kernarg_size 136
  .amdhsa_user_sgpr_count 2
  .amdhsa_user_sgpr_kernarg_segment_ptr 1
  .amdhsa_system_sgpr_workgroup_id_x 1
.end_amdhsa_kernel
```
